```python
import torch

def _softmax(x, axis=-1):
    return torch.softmax(x, dim=axis)
def _gelu(x):
    return torch.nn.functional.gelu(x, approximate="tanh")
def _silu(x):
    return torch.nn.functional.silu(x)
def _sigmoid(x):
    return torch.sigmoid(x)
def _layernorm(x, axis=-1, eps=1e-5):
    m = x.mean(dim=axis, keepdim=True)
    v = x.var(dim=axis, keepdim=True, unbiased=False)
    return (x - m) / torch.sqrt(v + eps)
def _scatter_add(tgt, idx, src, axis=0):
    return tgt.clone().index_add_(axis, idx, src)
def _segment_sum(src, seg, n):
    out = torch.zeros((n,) + src.shape[1:], dtype=src.dtype)
    return out.index_add_(0, seg, src)
def _pad(x, pw):
    flat = tuple(v for pair in reversed(pw) for v in pair)
    return torch.nn.functional.pad(x, flat)

kernel_name = 'sequential_preLN__sliding_local_dilated__glu_gated_glu__prompt'

def setup_inputs():

    _w = (lambda a: (lambda t: t.to(torch.bfloat16) if t.is_floating_point() else t)(torch.as_tensor(a)))
    def _A_setup():
        B, S, D = 1, 2048, 512
        return {
            "x": _w((lambda *s: torch.randn(*s, dtype=torch.bfloat16) * 0.05)(B, S, D)),
            "wqkv": _w((lambda *s: torch.randn(*s, dtype=torch.bfloat16) * 0.05)(D, 3 * D)),
            "wo": _w((lambda *s: torch.randn(*s, dtype=torch.bfloat16) * 0.05)(D, D)),
        }
    _A_in = _A_setup()

    def _B_setup():
        B, S, D, F = 1, 2048, 512, 1792
        return {
            "x": _w((lambda *s: torch.randn(*s, dtype=torch.bfloat16) * 0.05)(B, S, D)),
            "w_gate": _w((lambda *s: torch.randn(*s, dtype=torch.bfloat16) * 0.05)(D, F)),
            "w_up": _w((lambda *s: torch.randn(*s, dtype=torch.bfloat16) * 0.05)(D, F)),
            "w_down": _w((lambda *s: torch.randn(*s, dtype=torch.bfloat16) * 0.05)(F, D)),
        }
    _B_in = _B_setup()

    return {
        "A_x": _A_in["x"],
        "A_wqkv": _A_in["wqkv"],
        "A_wo": _A_in["wo"],
        "B_x": _B_in["x"],
        "B_w_gate": _B_in["w_gate"],
        "B_w_up": _B_in["w_up"],
        "B_w_down": _B_in["w_down"],
    }

def reference(A_x, A_wqkv, A_wo, B_x, B_w_gate, B_w_up, B_w_down):
    def _A_ref(x, wqkv, wo):
        B, S, D = x.shape
        H = 32; Dh = D // H
        W, dil = 8, 2
        qkv = (lambda x, *d: x.permute(*d))((x @ wqkv).reshape(B, S, 3, H, Dh), 2, 0, 3, 1, 4)
        q, k, v = qkv[0], qkv[1], qkv[2]
        scale = Dh ** -0.5
        pos = torch.arange(S)
        off = torch.arange(W) * dil
        idx = pos[:, None] - off[None, :]
        mask = idx >= 0
        idx_c = torch.where(mask, idx, 0).reshape(-1)
        kg = k[:, :, idx_c, :].reshape(B, H, S, W, Dh)
        vg = v[:, :, idx_c, :].reshape(B, H, S, W, Dh)
        logits = torch.einsum("bhsd,bhswd->bhsw", q, kg) * scale
        logits = torch.where(mask[None, None, :, :], logits, -1e9)
        attn = _softmax(logits, axis=-1)
        o = torch.einsum("bhsw,bhswd->bhsd", attn, vg)
        return (lambda x, *d: x.permute(*d))(o, 0, 2, 1, 3).reshape(B, S, D) @ wo

    def _B_ref(x, w_gate, w_up, w_down):
        g = torch.einsum("bsd,df->bsf", x, w_gate)
        u = torch.einsum("bsd,df->bsf", x, w_up)
        h = _sigmoid(g) * u
        return torch.einsum("bsf,fd->bsd", h, w_down)

    x = A_x
    h = x + _A_ref(_layernorm(x, axis=-1), A_wqkv, A_wo)
    h2 = h + _B_ref(_layernorm(h, axis=-1), B_w_gate, B_w_up, B_w_down)
    return h2
```

```asm
; @launch grid=(256,1,1) block=(256,1,1) lds=163840
.amdgcn_target "amdgcn-amd-amdhsa--gfx950"
.text
.globl sequential_preLN__sliding_local_dilated__glu_gated_glu__prompt_kernel
.p2align 8
.type sequential_preLN__sliding_local_dilated__glu_gated_glu__prompt_kernel,@function
sequential_preLN__sliding_local_dilated__glu_gated_glu__prompt_kernel:
    s_cmp_ge_u32 s2, 256
    s_cbranch_scc1 L_end
    s_load_dwordx4 s[4:7], s[0:1], 0
    s_load_dwordx4 s[32:35], s[0:1], 64
    s_load_dwordx2 s[40:41], s[0:1], 16
    s_load_dwordx4 s[44:47], s[0:1], 32
    s_load_dwordx4 s[48:51], s[0:1], 48
    v_lshrrev_b32 v12, 6, v0
    v_and_b32 v2, 63, v0
    v_readfirstlane_b32 s20, v12
    v_lshlrev_b32 v1, 4, v2
    s_getpc_b64 s[84:85]
L_pc0:
    s_sub_u32 s84, s84, L_pc0-sequential_preLN__sliding_local_dilated__glu_gated_glu__prompt_kernel
    s_subb_u32 s85, s85, 0
    s_and_b32 s85, s85, 0xffff
    s_mov_b32 s86, L_end-sequential_preLN__sliding_local_dilated__glu_gated_glu__prompt_kernel
    s_mov_b32 s87, 0x20000
    s_lshr_b32 s66, s2, 3
    s_lshl_b32 s66, s66, 2
    s_add_u32 s66, s66, s20
    s_mul_i32 s66, s66, 256
    v_lshlrev_b32 v228, 2, v2
    buffer_load_dword v229, v228, s[84:87], s66 offen
    s_and_b32 s21, s2, 7
    s_lshl_b32 s21, s21, 1
    s_bfe_u32 s27, s2, 0x10003
    s_add_u32 s21, s21, s27
    s_lshr_b32 s22, s2, 4
    s_add_u32 s3, s2, 128
    s_sub_u32 s27, s2, 32
    s_cmp_lt_u32 s2, 128
    s_cselect_b32 s3, s3, s27
    s_cmp_lt_u32 s2, 96
    s_cselect_b32 s3, s2, s3
    s_and_b32 s24, s22, 1
    s_lshr_b32 s25, s22, 1
    s_lshl_b32 s26, s21, 1
    s_add_u32 s26, s26, s24
    v_lshrrev_b32 v12, 3, v2
    v_and_b32 v13, 7, v2
    v_xor_b32 v14, v13, v12
    v_lshlrev_b32 v14, 4, v14
    v_lshl_add_u32 v3, v12, 10, v14
    v_bfe_u32 v14, v12, 1, 1
    v_lshrrev_b32 v15, 1, v13
    v_xor_b32 v14, v14, v15
    v_lshlrev_b32 v14, 5, v14
    v_and_b32 v15, 1, v13
    v_lshl_add_u32 v14, v15, 4, v14
    v_mul_u32_u24 v15, 3072, v12
    v_add_u32 v4, v14, v15
    v_xor_b32 v5, 64, v4
    s_lshl_b32 s27, s26, 16
    s_lshl_b32 s28, s20, 13
    s_add_u32 s31, s27, s28
    s_add_u32 s31, s31, 16384
    s_sub_u32 s30, s31, 32768
    s_cmp_eq_u32 s26, 0
    s_cselect_b32 s29, 1, 0
    s_cmp_lt_u32 s20, 2
    s_cselect_b32 s29, s29, 0
    s_cmp_eq_u32 s29, 1
    s_cselect_b32 s30, s28, s30
    s_add_u32 s36, s31, 32768
    s_lshl_b32 s37, s20, 10
    s_add_u32 s38, s37, 8192
    s_add_u32 s27, s37, 4096
    s_cmp_lt_u32 s20, 2
    s_cselect_b32 s36, s36, s31
    s_cselect_b32 s38, s38, s27
    s_cselect_b32 s60, -1, 1
    s_cselect_b32 s61, -1, 0
    s_mul_i32 s27, s20, 49152
    s_lshl_b32 s28, s25, 7
    s_add_u32 s52, s27, s28
    s_add_u32 s53, s52, 23552
    s_add_u32 s54, s52, 1024
    s_add_u32 s55, s53, 1024
    s_add_u32 s56, s52, 2048
    s_add_u32 s57, s53, 2048
    s_lshl_b32 s39, s20, 11
    s_add_u32 s39, s39, 10240
    s_cmp_eq_u32 s20, 0
    s_cselect_b32 s58, 0xffff0000, -1
    s_mov_b32 s59, -1
    s_waitcnt lgkmcnt(0)
    s_mov_b32 s16, s32
    s_and_b32 s17, s33, 0xffff
    s_mov_b32 s18, 0x100
    s_mov_b32 s19, 0x20000
    s_mov_b32 s8, s34
    s_and_b32 s9, s35, 0xffff
    s_mov_b32 s10, 0x1320000
    s_mov_b32 s11, 0x20000
    s_mov_b32 s12, s6
    s_and_b32 s13, s7, 0xffff
    s_mov_b32 s14, 0x180000
    s_mov_b32 s15, 0x20000
    s_and_b32 s5, s5, 0xffff
    s_mov_b32 s6, 0x200000
    s_mov_b32 s7, 0x20000
    s_cmp_lg_u32 s2, 0
    s_cbranch_scc1 L_nononce
    s_cmp_lg_u32 s20, 0
    s_cbranch_scc1 L_nononce
    s_memrealtime s[66:67]
    s_waitcnt lgkmcnt(0)
    s_or_b32 s66, s66, 1
    v_mov_b32 v12, s66
    v_mov_b32 v13, 0
    buffer_store_dword v12, v13, s[16:19], 0 offen sc1
L_nononce:
    s_mul_i32 s62, s3, 2341
    s_lshr_b32 s62, s62, 16
    s_mul_i32 s27, s62, 28
    s_sub_u32 s63, s3, s27
    s_lshl_b32 s27, s2, 2
    s_add_u32 s27, s27, s20
    s_mul_i32 s27, s27, 1536
    buffer_load_dwordx4 v[200:203], v1, s[12:15], s27 offen
    buffer_load_dwordx4 v[204:207], v1, s[12:15], s27 offen offset:1024
    s_lshl_b32 s65, s21, 4
    s_add_u32 s65, s65, s22
    s_lshl_b32 s65, s65, 2
    s_add_u32 s65, s65, s20
    s_lshl_b32 s65, s65, 1
    s_lshl_b32 s27, s65, 10
    buffer_load_dwordx4 v[140:143], v1, s[4:7], s27 offen
    buffer_load_dwordx4 v[144:147], v1, s[4:7], s27 offen offset:1024
    v_mov_b32 v220, v3
    v_mov_b32 v221, v4
    s_and_b32 s90, s25, 7
    s_lshl_b32 s27, s90, 7
    s_mul_i32 s28, s90, 196608
    v_add_u32 v3, s27, v220
    v_add_u32 v4, s28, v221
    v_xor_b32 v5, 64, v4
    s_add_u32 m0, s37, 0
    s_mov_b64 exec, s[58:59]
    buffer_load_dwordx4 v3, s[4:7], s30 offen lds
    s_mov_b64 exec, -1
    s_add_u32 m0, s37, 4096
    s_nop 0
    buffer_load_dwordx4 v3, s[4:7], s31 offen lds
    s_add_u32 m0, s38, 0
    s_mov_b64 exec, s[60:61]
    buffer_load_dwordx4 v3, s[4:7], s36 offen lds
    s_mov_b64 exec, -1
    s_add_u32 m0, s39, 0
    s_nop 0
    buffer_load_dwordx4 v4, s[12:15], s52 offen lds
    buffer_load_dwordx4 v5, s[12:15], s53 offen offset:1024 lds
    s_add_u32 m0, s39, 8192
    s_nop 0
    buffer_load_dwordx4 v4, s[12:15], s54 offen lds
    buffer_load_dwordx4 v5, s[12:15], s55 offen offset:1024 lds
    s_add_u32 m0, s39, 16384
    s_nop 0
    buffer_load_dwordx4 v4, s[12:15], s56 offen lds
    buffer_load_dwordx4 v5, s[12:15], s57 offen offset:1024 lds
    s_add_u32 s90, s90, 1
    s_and_b32 s90, s90, 7
    s_lshl_b32 s91, s90, 7
    s_mul_i32 s92, s90, 196608
    v_add_u32 v3, s91, v220
    v_add_u32 v4, s92, v221
    v_xor_b32 v5, 64, v4
    s_add_u32 m0, s37, 34816
    s_mov_b64 exec, s[58:59]
    buffer_load_dwordx4 v3, s[4:7], s30 offen lds
    s_mov_b64 exec, -1
    s_add_u32 m0, s37, 38912
    s_nop 0
    buffer_load_dwordx4 v3, s[4:7], s31 offen lds
    s_add_u32 m0, s38, 34816
    s_mov_b64 exec, s[60:61]
    buffer_load_dwordx4 v3, s[4:7], s36 offen lds
    s_mov_b64 exec, -1
    s_add_u32 m0, s39, 34816
    s_nop 0
    buffer_load_dwordx4 v4, s[12:15], s52 offen lds
    buffer_load_dwordx4 v5, s[12:15], s53 offen offset:1024 lds
    s_add_u32 m0, s39, 43008
    s_nop 0
    buffer_load_dwordx4 v4, s[12:15], s54 offen lds
    buffer_load_dwordx4 v5, s[12:15], s55 offen offset:1024 lds
    s_add_u32 m0, s39, 51200
    s_nop 0
    buffer_load_dwordx4 v4, s[12:15], s56 offen lds
    buffer_load_dwordx4 v5, s[12:15], s57 offen offset:1024 lds
    s_add_u32 s90, s90, 1
    s_and_b32 s90, s90, 7
    s_lshl_b32 s91, s90, 7
    s_mul_i32 s92, s90, 196608
    v_add_u32 v3, s91, v220
    v_add_u32 v4, s92, v221
    v_xor_b32 v5, 64, v4
    v_mov_b32 v149, 0
    v_mov_b32 v148, 0
    s_cmp_lg_u32 s20, 0
    s_cbranch_scc1 L_nonl
    s_mov_b64 exec, 1
    buffer_load_dword v148, v149, s[16:19], 0 offen sc1
    s_mov_b64 exec, -1
L_nonl:
    v_and_b32 v12, 15, v2
    v_lshrrev_b32 v13, 4, v2
    v_and_b32 v14, 7, v12
    v_xor_b32 v14, v14, v13
    v_lshlrev_b32 v14, 4, v14
    v_lshl_add_u32 v6, v12, 7, v14
    v_xor_b32 v7, 64, v6
    v_add_u32 v8, 69632, v6
    v_add_u32 v9, 69632, v7
    v_lshrrev_b32 v14, 2, v12
    v_lshl_add_u32 v14, v13, 3, v14
    v_lshlrev_b32 v14, 7, v14
    v_bfe_u32 v15, v12, 3, 1
    v_and_b32 v10, 1, v13
    v_lshl_or_b32 v15, v10, 1, v15
    v_xor_b32 v15, s20, v15
    v_lshl_add_u32 v14, v15, 5, v14
    v_and_b32 v15, 3, v12
    v_lshl_add_u32 v14, v15, 3, v14
    v_add_u32 v10, 10240, v14
    v_add_u32 v11, 69632, v10
    v_mov_b32 v239, 0x3f803f80
    v_mov_b32 v185, 0
    v_mov_b32 v194, 0
    v_mov_b32 v197, 0
    v_mov_b32 v253, 0
    v_lshrrev_b32 v12, 4, v0
    v_mul_u32_u24 v12, 34816, v12
    v_and_b32 v13, 15, v0
    v_lshl_add_u32 v12, v13, 4, v12
    v_mov_b32 v76, v239
    v_mov_b32 v77, v239
    v_mov_b32 v78, v239
    v_mov_b32 v79, v239
    v_cmp_gt_u32 vcc, 64, v0
    s_and_saveexec_b64 s[66:67], vcc
    s_cbranch_execz L_noinit
    ds_write_b128 v12, v[76:79]
L_noinit:
    s_mov_b64 exec, s[66:67]
    v_mov_b32 v16, 0
    v_mov_b32 v17, 0
    v_mov_b32 v18, 0
    v_mov_b32 v19, 0
    v_mov_b32 v20, 0
    v_mov_b32 v21, 0
    v_mov_b32 v22, 0
    v_mov_b32 v23, 0
    v_mov_b32 v24, 0
    v_mov_b32 v25, 0
    v_mov_b32 v26, 0
    v_mov_b32 v27, 0
    v_mov_b32 v28, 0
    v_mov_b32 v29, 0
    v_mov_b32 v30, 0
    v_mov_b32 v31, 0
    v_mov_b32 v32, 0
    v_mov_b32 v33, 0
    v_mov_b32 v34, 0
    v_mov_b32 v35, 0
    v_mov_b32 v36, 0
    v_mov_b32 v37, 0
    v_mov_b32 v38, 0
    v_mov_b32 v39, 0
    v_mov_b32 v40, 0
    v_mov_b32 v41, 0
    v_mov_b32 v42, 0
    v_mov_b32 v43, 0
    v_mov_b32 v44, 0
    v_mov_b32 v45, 0
    v_mov_b32 v46, 0
    v_mov_b32 v47, 0
    v_mov_b32 v48, 0
    v_mov_b32 v49, 0
    v_mov_b32 v50, 0
    v_mov_b32 v51, 0
    v_mov_b32 v52, 0
    v_mov_b32 v53, 0
    v_mov_b32 v54, 0
    v_mov_b32 v55, 0
    v_mov_b32 v56, 0
    v_mov_b32 v57, 0
    v_mov_b32 v58, 0
    v_mov_b32 v59, 0
    v_mov_b32 v60, 0
    v_mov_b32 v61, 0
    v_mov_b32 v62, 0
    v_mov_b32 v63, 0
    v_mov_b32 v64, 0
    v_mov_b32 v65, 0
    v_mov_b32 v66, 0
    v_mov_b32 v67, 0
    v_mov_b32 v68, 0
    v_mov_b32 v69, 0
    v_mov_b32 v70, 0
    v_mov_b32 v71, 0
    v_mov_b32 v72, 0
    v_mov_b32 v73, 0
    v_mov_b32 v74, 0
    v_mov_b32 v75, 0
    s_waitcnt vmcnt(18)
    v_mov_b32 v150, 0
    v_mov_b32 v151, 0
    v_mov_b32 v152, 0
    v_mov_b32 v153, 0
    v_dot2c_f32_bf16 v150, v140, v239
    v_dot2c_f32_bf16 v151, v140, v140
    v_dot2c_f32_bf16 v152, v144, v239
    v_dot2c_f32_bf16 v153, v144, v144
    v_dot2c_f32_bf16 v150, v141, v239
    v_dot2c_f32_bf16 v151, v141, v141
    v_dot2c_f32_bf16 v152, v145, v239
    v_dot2c_f32_bf16 v153, v145, v145
    v_dot2c_f32_bf16 v150, v142, v239
    v_dot2c_f32_bf16 v151, v142, v142
    v_dot2c_f32_bf16 v152, v146, v239
    v_dot2c_f32_bf16 v153, v146, v146
    v_dot2c_f32_bf16 v150, v143, v239
    v_dot2c_f32_bf16 v151, v143, v143
    v_dot2c_f32_bf16 v152, v147, v239
    v_dot2c_f32_bf16 v153, v147, v147
    s_nop 2
    v_add_f32_dpp v150, v150, v150 row_ror:8 row_mask:0xf bank_mask:0xf
    v_add_f32_dpp v151, v151, v151 row_ror:8 row_mask:0xf bank_mask:0xf
    v_add_f32_dpp v152, v152, v152 row_ror:8 row_mask:0xf bank_mask:0xf
    v_add_f32_dpp v153, v153, v153 row_ror:8 row_mask:0xf bank_mask:0xf
    v_add_f32_dpp v150, v150, v150 row_ror:4 row_mask:0xf bank_mask:0xf
    v_add_f32_dpp v151, v151, v151 row_ror:4 row_mask:0xf bank_mask:0xf
    v_add_f32_dpp v152, v152, v152 row_ror:4 row_mask:0xf bank_mask:0xf
    v_add_f32_dpp v153, v153, v153 row_ror:4 row_mask:0xf bank_mask:0xf
    v_add_f32_dpp v150, v150, v150 row_ror:2 row_mask:0xf bank_mask:0xf
    v_add_f32_dpp v151, v151, v151 row_ror:2 row_mask:0xf bank_mask:0xf
    v_add_f32_dpp v152, v152, v152 row_ror:2 row_mask:0xf bank_mask:0xf
    v_add_f32_dpp v153, v153, v153 row_ror:2 row_mask:0xf bank_mask:0xf
    v_add_f32_dpp v150, v150, v150 row_ror:1 row_mask:0xf bank_mask:0xf
    v_add_f32_dpp v151, v151, v151 row_ror:1 row_mask:0xf bank_mask:0xf
    v_add_f32_dpp v152, v152, v152 row_ror:1 row_mask:0xf bank_mask:0xf
    v_add_f32_dpp v153, v153, v153 row_ror:1 row_mask:0xf bank_mask:0xf
    v_mov_b32 v154, v150
    v_mov_b32 v155, v151
    v_mov_b32 v156, v152
    v_mov_b32 v157, v153
    s_nop 0
    v_permlane16_swap_b32 v150, v154
    v_permlane16_swap_b32 v151, v155
    v_permlane16_swap_b32 v152, v156
    v_permlane16_swap_b32 v153, v157
    s_nop 0
    v_add_f32 v150, v150, v154
    v_add_f32 v151, v151, v155
    v_add_f32 v152, v152, v156
    v_add_f32 v153, v153, v157
    v_mov_b32 v154, v150
    v_mov_b32 v155, v151
    v_mov_b32 v156, v152
    v_mov_b32 v157, v153
    s_nop 0
    v_permlane32_swap_b32 v150, v154
    v_permlane32_swap_b32 v151, v155
    v_permlane32_swap_b32 v152, v156
    v_permlane32_swap_b32 v153, v157
    s_nop 0
    v_add_f32 v150, v150, v154
    v_add_f32 v151, v151, v155
    v_add_f32 v152, v152, v156
    v_add_f32 v153, v153, v157
    v_cmp_eq_u32 vcc, 1, v2
    s_nop 1
    v_cndmask_b32 v150, v150, v152, vcc
    v_cndmask_b32 v151, v151, v153, vcc
    v_mul_f32 v150, 0x3b000000, v150
    v_mul_f32 v151, 0x3b000000, v151
    v_fma_f32 v151, -v150, v150, v151
    v_add_f32 v151, 0x3727c5ac, v151
    v_rsq_f32 v156, v151
    s_nop 0
    v_mul_f32 v158, v150, v156
    s_waitcnt vmcnt(9) lgkmcnt(0)
    s_barrier
    ds_read_b64_tr_b16 v[96:97], v10 offset:0
    ds_read_b64_tr_b16 v[98:99], v10 offset:512
    ds_read_b64_tr_b16 v[100:101], v10 offset:8192
    ds_read_b64_tr_b16 v[102:103], v10 offset:8704
    ds_read_b64_tr_b16 v[104:105], v10 offset:16384
    ds_read_b64_tr_b16 v[106:107], v10 offset:16896
    ds_read_b128 v[76:79], v6 offset:0
    ds_read_b128 v[80:83], v6 offset:2048
    ds_read_b128 v[84:87], v6 offset:4096
    ds_read_b128 v[88:91], v6 offset:6144
    ds_read_b128 v[92:95], v6 offset:8192
    s_cmp_lt_u32 s3, 224
    s_cbranch_scc1 L_pdw
    v_lshrrev_b32 v14, 3, v2
    v_and_b32 v15, 7, v2
    v_lshlrev_b32 v15, 4, v15
    v_lshl_add_u32 v13, v14, 10, v15
    s_mov_b32 s68, s40
    s_and_b32 s69, s41, 0xffff
    s_mov_b32 s70, 0x80000
    s_mov_b32 s71, 0x20000
    s_sub_u32 s64, s3, 224
    s_lshl_b32 s64, s64, 1
    s_and_b32 s82, s64, 7
    s_lshl_b32 s82, s82, 6
    s_lshl_b32 s28, s20, 4
    s_add_u32 s82, s82, s28
    s_lshl_b32 s82, s82, 10
    s_lshr_b32 s28, s64, 3
    s_lshl_b32 s28, s28, 7
    s_add_u32 s82, s82, s28
    s_add_u32 s83, s82, 7168
    s_lshl_b32 s27, s20, 11
    s_add_u32 m0, s27, 139264
    s_nop 0
    buffer_load_dwordx4 v13, s[68:71], s82 offen nt lds
    buffer_load_dwordx4 v13, s[68:71], s83 offen offset:1024 nt lds
    s_add_u32 s82, s82, 65536
    s_add_u32 s83, s83, 65536
    s_add_u32 m0, s27, 147456
    s_nop 0
    buffer_load_dwordx4 v13, s[68:71], s82 offen nt lds
    buffer_load_dwordx4 v13, s[68:71], s83 offen offset:1024 nt lds
L_pdw:
    s_getreg_b32 s93, hwreg(HW_REG_XCC_ID)
    s_and_b32 s93, s93, 15
    s_waitcnt lgkmcnt(0)
    v_mfma_f32_16x16x32_bf16 v[16:19], v[96:99], v[76:79], v[16:19]
    ds_read_b64_tr_b16 v[128:129], v10 offset:4096
    ds_read_b64_tr_b16 v[130:131], v10 offset:4608
    s_add_u32 m0, s37, 69632
    s_mov_b64 exec, s[58:59]
    buffer_load_dwordx4 v3, s[4:7], s30 offen lds
    s_mov_b64 exec, -1
    v_mfma_f32_16x16x32_bf16 v[36:39], v[100:103], v[76:79], v[36:39]
    ds_read_b64_tr_b16 v[132:133], v10 offset:12288
    ds_read_b64_tr_b16 v[134:135], v10 offset:12800
    s_add_u32 m0, s37, 73728
    s_nop 0
    buffer_load_dwordx4 v3, s[4:7], s31 offen lds
    v_mfma_f32_16x16x32_bf16 v[56:59], v[104:107], v[76:79], v[56:59]
    ds_read_b64_tr_b16 v[136:137], v10 offset:20480
    ds_read_b64_tr_b16 v[138:139], v10 offset:20992
    v_mfma_f32_16x16x32_bf16 v[20:23], v[96:99], v[80:83], v[20:23]
    ds_read_b128 v[108:111], v7 offset:0
    ds_read_b128 v[112:115], v7 offset:2048
    s_add_u32 m0, s38, 69632
    s_mov_b64 exec, s[60:61]
    buffer_load_dwordx4 v3, s[4:7], s36 offen lds
    s_mov_b64 exec, -1
    v_mfma_f32_16x16x32_bf16 v[40:43], v[100:103], v[80:83], v[40:43]
    ds_read_b128 v[116:119], v7 offset:4096
    ds_read_b128 v[120:123], v7 offset:6144
    s_add_u32 m0, s39, 69632
    s_nop 0
    buffer_load_dwordx4 v4, s[12:15], s52 offen lds
    v_mfma_f32_16x16x32_bf16 v[60:63], v[104:107], v[80:83], v[60:63]
    ds_read_b128 v[124:127], v7 offset:8192
    v_mfma_f32_16x16x32_bf16 v[24:27], v[96:99], v[84:87], v[24:27]
    buffer_load_dwordx4 v5, s[12:15], s53 offen offset:1024 lds
    v_mfma_f32_16x16x32_bf16 v[44:47], v[100:103], v[84:87], v[44:47]
    s_add_u32 m0, s39, 77824
    s_nop 0
    buffer_load_dwordx4 v4, s[12:15], s54 offen lds
    v_mfma_f32_16x16x32_bf16 v[64:67], v[104:107], v[84:87], v[64:67]
    v_mfma_f32_16x16x32_bf16 v[28:31], v[96:99], v[88:91], v[28:31]
    buffer_load_dwordx4 v5, s[12:15], s55 offen offset:1024 lds
    v_mfma_f32_16x16x32_bf16 v[48:51], v[100:103], v[88:91], v[48:51]
    s_add_u32 m0, s39, 86016
    s_nop 0
    buffer_load_dwordx4 v4, s[12:15], s56 offen lds
    v_mfma_f32_16x16x32_bf16 v[68:71], v[104:107], v[88:91], v[68:71]
    v_mfma_f32_16x16x32_bf16 v[32:35], v[96:99], v[92:95], v[32:35]
    buffer_load_dwordx4 v5, s[12:15], s57 offen offset:1024 lds
    s_add_u32 s90, s90, 1
    s_and_b32 s90, s90, 7
    s_lshl_b32 s91, s90, 7
    s_mul_i32 s92, s90, 196608
    v_add_u32 v3, s91, v220
    v_add_u32 v4, s92, v221
    v_xor_b32 v5, 64, v4
    v_mfma_f32_16x16x32_bf16 v[52:55], v[100:103], v[92:95], v[52:55]
    s_cmp_lg_u32 s20, 3
    s_cbranch_scc1 L_cp_1
    s_getpc_b64 s[66:67]
    s_and_b32 s66, s66, 0xffffff00
    s_mov_b32 s84, s66
    s_and_b32 s85, s67, 0xffff
    s_mov_b32 s86, 17408
    s_mov_b32 s87, 0x20000
    s_lshr_b32 s66, s2, 3
    s_lshl_b32 s66, s66, 10
    buffer_load_dwordx4 v[228:231], v1, s[84:87], s66 offen
L_cp_1:
    v_mfma_f32_16x16x32_bf16 v[72:75], v[104:107], v[92:95], v[72:75]
    s_waitcnt vmcnt(13)
    s_cmp_ge_u32 s3, 224
    s_cbranch_scc1 L_wv_2
    s_waitcnt vmcnt(9)
L_wv_2:
    s_waitcnt lgkmcnt(0)
    s_cmp_lg_u32 s20, 0
    s_cbranch_scc1 L_ns_5
    s_mov_b32 s29, 0
    s_mov_b64 exec, 1
    s_branch L_nc_6
L_np_3:
    buffer_load_dword v148, v149, s[16:19], 0 offen sc1
    s_add_u32 s29, s29, 1
    s_waitcnt vmcnt(0)
L_nc_6:
    s_memrealtime s[66:67]
    v_readfirstlane_b32 s23, v148
    s_waitcnt lgkmcnt(0)
    s_cmp_ge_u32 s29, 32768
    s_cbranch_scc1 L_nd_4
    s_cmp_eq_u32 s23, 0
    s_cbranch_scc1 L_np_3
    s_cmp_ge_u32 s29, 64
    s_cbranch_scc1 L_nd_4
    s_add_u32 s66, s66, 2
    s_sub_u32 s66, s66, s23
    s_cmp_ge_u32 s66, 1500
    s_cbranch_scc1 L_np_3
L_nd_4:
    s_mov_b64 exec, -1
    v_mov_b32 v148, s23
    v_mov_b32 v149, 104576
    ds_write_b32 v149, v148
    s_waitcnt lgkmcnt(0)
L_ns_5:
    s_barrier
    s_cmp_ge_u32 s3, 224
    s_cbranch_scc1 L_pdn
    v_lshrrev_b32 v14, 3, v2
    v_and_b32 v15, 7, v2
    v_lshlrev_b32 v15, 4, v15
    s_mov_b32 s68, s44
    s_and_b32 s69, s45, 0xffff
    s_mov_b32 s70, 0x1c0000
    s_mov_b32 s71, 0x20000
    s_mov_b32 s72, s46
    s_and_b32 s73, s47, 0xffff
    s_mov_b32 s74, 0x1c0000
    s_mov_b32 s75, 0x20000
    v_mul_u32_u24 v12, 3584, v14
    v_add_u32 v12, v12, v15
    s_lshl_b32 s27, s62, 6
    s_lshl_b32 s28, s20, 4
    s_add_u32 s27, s27, s28
    s_mul_i32 s27, s27, 3584
    s_lshl_b32 s28, s63, 7
    s_add_u32 s80, s27, s28
    s_add_u32 s81, s80, 27648
    s_lshl_b32 s27, s20, 11
    s_add_u32 m0, s27, 139264
    s_nop 0
    buffer_load_dwordx4 v12, s[68:71], s80 offen nt lds
    buffer_load_dwordx4 v12, s[68:71], s81 offen offset:1024 nt lds
    s_add_u32 m0, s27, 147456
    s_nop 0
    buffer_load_dwordx4 v12, s[72:75], s80 offen nt lds
    buffer_load_dwordx4 v12, s[72:75], s81 offen offset:1024 nt lds
L_pdn:
    s_waitcnt lgkmcnt(0)
    v_mfma_f32_16x16x32_bf16 v[16:19], v[128:131], v[108:111], v[16:19]
    ds_read_b64_tr_b16 v[96:97], v10 offset:34816
    ds_read_b64_tr_b16 v[98:99], v10 offset:35328
    s_add_u32 m0, s37, 104448
    s_mov_b64 exec, s[58:59]
    buffer_load_dwordx4 v3, s[4:7], s30 offen lds
    s_mov_b64 exec, -1
    v_mfma_f32_16x16x32_bf16 v[36:39], v[132:135], v[108:111], v[36:39]
    ds_read_b64_tr_b16 v[100:101], v10 offset:43008
    ds_read_b64_tr_b16 v[102:103], v10 offset:43520
    v_mfma_f32_16x16x32_bf16 v[56:59], v[136:139], v[108:111], v[56:59]
    ds_read_b64_tr_b16 v[104:105], v10 offset:51200
    ds_read_b64_tr_b16 v[106:107], v10 offset:51712
    v_mfma_f32_16x16x32_bf16 v[20:23], v[128:131], v[112:115], v[20:23]
    ds_read_b128 v[76:79], v6 offset:34816
    ds_read_b128 v[80:83], v6 offset:36864
    s_add_u32 m0, s37, 108544
    s_nop 0
    buffer_load_dwordx4 v3, s[4:7], s31 offen lds
    v_mfma_f32_16x16x32_bf16 v[40:43], v[132:135], v[112:115], v[40:43]
    ds_read_b128 v[84:87], v6 offset:38912
    ds_read_b128 v[88:91], v6 offset:40960
    v_mfma_f32_16x16x32_bf16 v[60:63], v[136:139], v[112:115], v[60:63]
    ds_read_b128 v[92:95], v6 offset:43008
    v_mfma_f32_16x16x32_bf16 v[24:27], v[128:131], v[116:119], v[24:27]
    s_add_u32 m0, s38, 104448
    s_mov_b64 exec, s[60:61]
    buffer_load_dwordx4 v3, s[4:7], s36 offen lds
    s_mov_b64 exec, -1
    v_mfma_f32_16x16x32_bf16 v[44:47], v[132:135], v[116:119], v[44:47]
    v_mfma_f32_16x16x32_bf16 v[64:67], v[136:139], v[116:119], v[64:67]
    v_mfma_f32_16x16x32_bf16 v[28:31], v[128:131], v[120:123], v[28:31]
    s_add_u32 m0, s39, 104448
    s_nop 0
    buffer_load_dwordx4 v4, s[12:15], s52 offen lds
    v_mfma_f32_16x16x32_bf16 v[48:51], v[132:135], v[120:123], v[48:51]
    v_mfma_f32_16x16x32_bf16 v[68:71], v[136:139], v[120:123], v[68:71]
    v_mfma_f32_16x16x32_bf16 v[32:35], v[128:131], v[124:127], v[32:35]
    buffer_load_dwordx4 v5, s[12:15], s53 offen offset:1024 lds
    v_mfma_f32_16x16x32_bf16 v[52:55], v[132:135], v[124:127], v[52:55]
    v_mfma_f32_16x16x32_bf16 v[72:75], v[136:139], v[124:127], v[72:75]
    s_waitcnt lgkmcnt(0)
    v_mfma_f32_16x16x32_bf16 v[16:19], v[96:99], v[76:79], v[16:19]
    ds_read_b64_tr_b16 v[128:129], v10 offset:38912
    ds_read_b64_tr_b16 v[130:131], v10 offset:39424
    s_add_u32 m0, s39, 112640
    s_nop 0
    buffer_load_dwordx4 v4, s[12:15], s54 offen lds
    v_mfma_f32_16x16x32_bf16 v[36:39], v[100:103], v[76:79], v[36:39]
    ds_read_b64_tr_b16 v[132:133], v10 offset:47104
    ds_read_b64_tr_b16 v[134:135], v10 offset:47616
    v_mfma_f32_16x16x32_bf16 v[56:59], v[104:107], v[76:79], v[56:59]
    ds_read_b64_tr_b16 v[136:137], v10 offset:55296
    ds_read_b64_tr_b16 v[138:139], v10 offset:55808
    v_mfma_f32_16x16x32_bf16 v[20:23], v[96:99], v[80:83], v[20:23]
    ds_read_b128 v[108:111], v7 offset:34816
    ds_read_b128 v[112:115], v7 offset:36864
    buffer_load_dwordx4 v5, s[12:15], s55 offen offset:1024 lds
    v_mfma_f32_16x16x32_bf16 v[40:43], v[100:103], v[80:83], v[40:43]
    ds_read_b128 v[116:119], v7 offset:38912
    ds_read_b128 v[120:123], v7 offset:40960
    v_mfma_f32_16x16x32_bf16 v[60:63], v[104:107], v[80:83], v[60:63]
    ds_read_b128 v[124:127], v7 offset:43008
    v_mfma_f32_16x16x32_bf16 v[24:27], v[96:99], v[84:87], v[24:27]
    v_mfma_f32_16x16x32_bf16 v[44:47], v[100:103], v[84:87], v[44:47]
    s_add_u32 m0, s39, 120832
    s_nop 0
    buffer_load_dwordx4 v4, s[12:15], s56 offen lds
    v_mfma_f32_16x16x32_bf16 v[64:67], v[104:107], v[84:87], v[64:67]
    v_mfma_f32_16x16x32_bf16 v[28:31], v[96:99], v[88:91], v[28:31]
    v_mfma_f32_16x16x32_bf16 v[48:51], v[100:103], v[88:91], v[48:51]
    v_mfma_f32_16x16x32_bf16 v[68:71], v[104:107], v[88:91], v[68:71]
    buffer_load_dwordx4 v5, s[12:15], s57 offen offset:1024 lds
    s_add_u32 s90, s90, 1
    s_and_b32 s90, s90, 7
    s_lshl_b32 s91, s90, 7
    s_mul_i32 s92, s90, 196608
    v_add_u32 v3, s91, v220
    v_add_u32 v4, s92, v221
    v_xor_b32 v5, 64, v4
    v_mfma_f32_16x16x32_bf16 v[32:35], v[96:99], v[92:95], v[32:35]
    v_mfma_f32_16x16x32_bf16 v[52:55], v[100:103], v[92:95], v[52:55]
    v_mfma_f32_16x16x32_bf16 v[72:75], v[104:107], v[92:95], v[72:75]
    s_waitcnt vmcnt(13)
    s_cmp_lt_u32 s3, 224
    s_cbranch_scc1 L_wv_7
    s_waitcnt vmcnt(9)
L_wv_7:
    s_waitcnt lgkmcnt(0)
    s_barrier
    v_mov_b32 v149, 104576
    ds_read_b32 v148, v149
    s_lshl_b32 s27, s65, 4
    s_add_u32 s27, s27, 0x1310000
    s_waitcnt lgkmcnt(0)
    v_readfirstlane_b32 s23, v148
    v_mov_b32 v157, v148
    v_mov_b32 v159, v148
    s_mov_b64 exec, 3
    buffer_store_dwordx4 v[156:159], v1, s[8:11], s27 offen sc1
    s_mov_b64 exec, -1
    s_cmp_lg_u32 s20, 0
    s_cbranch_scc1 L_fx_8
    s_add_u32 s27, s23, s93
    v_mov_b32 v186, s27
    s_lshl_b32 s27, s21, 7
    s_lshl_b32 s28, s22, 2
    s_add_u32 s27, s27, s28
    s_add_u32 s27, s27, 0x1304000
    v_mov_b32 v187, 0
    s_mov_b64 exec, 1
    buffer_store_dword v186, v187, s[8:11], s27 offen sc1
    s_mov_b64 exec, -1
L_fx_8:
    s_cmp_lt_u32 s3, 224
    s_cbranch_scc1 L_wdone
    v_and_b32 v184, 15, v2
    v_bfe_u32 v185, v2, 4, 1
    v_lshrrev_b32 v186, 5, v2
    v_lshrrev_b32 v187, 2, v184
    v_lshlrev_b32 v187, 7, v187
    v_and_b32 v188, 3, v184
    v_lshl_add_u32 v187, v188, 3, v187
    v_lshlrev_b32 v189, 5, v185
    v_lshl_add_u32 v189, v186, 10, v189
    v_add_u32 v189, v189, v187
    s_and_b32 s27, s20, 1
    s_lshl_b32 s27, s27, 6
    s_lshr_b32 s28, s20, 1
    s_lshl_b32 s28, s28, 12
    s_add_u32 s27, s27, s28
    s_add_u32 s27, s27, 139264
    v_add_u32 v189, s27, v189
    ds_read_b64_tr_b16 v[160:161], v189 offset:0
    ds_read_b64_tr_b16 v[162:163], v189 offset:512
    ds_read_b64_tr_b16 v[164:165], v189 offset:2048
    ds_read_b64_tr_b16 v[166:167], v189 offset:2560
    ds_read_b64_tr_b16 v[168:169], v189 offset:8192
    ds_read_b64_tr_b16 v[170:171], v189 offset:8704
    ds_read_b64_tr_b16 v[172:173], v189 offset:10240
    ds_read_b64_tr_b16 v[174:175], v189 offset:10752
    s_lshr_b32 s27, s64, 3
    s_lshl_b32 s27, s27, 1
    s_and_b32 s28, s20, 1
    s_add_u32 s27, s27, s28
    s_lshl_b32 s27, s27, 15
    s_and_b32 s28, s64, 7
    s_lshl_b32 s28, s28, 12
    s_add_u32 s27, s27, s28
    s_lshr_b32 s28, s20, 1
    s_lshl_b32 s28, s28, 11
    s_add_u32 s27, s27, s28
    s_add_u32 s88, s27, 0x480000
    s_add_u32 s89, s88, 4096
    s_waitcnt lgkmcnt(0)
    buffer_store_dwordx4 v[160:163], v1, s[8:11], s88 offen offset:0 sc1
    buffer_store_dwordx4 v[164:167], v1, s[8:11], s88 offen offset:1024 sc1
    buffer_store_dwordx4 v[168:171], v1, s[8:11], s89 offen offset:0 sc1
    buffer_store_dwordx4 v[172:175], v1, s[8:11], s89 offen offset:1024 sc1
L_wdone:
    s_waitcnt lgkmcnt(0)
    v_mfma_f32_16x16x32_bf16 v[16:19], v[128:131], v[108:111], v[16:19]
    ds_read_b64_tr_b16 v[96:97], v11 offset:0
    ds_read_b64_tr_b16 v[98:99], v11 offset:512
    s_add_u32 m0, s37, 0
    s_mov_b64 exec, s[58:59]
    buffer_load_dwordx4 v3, s[4:7], s30 offen lds
    s_mov_b64 exec, -1
    v_mfma_f32_16x16x32_bf16 v[36:39], v[132:135], v[108:111], v[36:39]
    ds_read_b64_tr_b16 v[100:101], v11 offset:8192
    ds_read_b64_tr_b16 v[102:103], v11 offset:8704
    v_mfma_f32_16x16x32_bf16 v[56:59], v[136:139], v[108:111], v[56:59]
    ds_read_b64_tr_b16 v[104:105], v11 offset:16384
    ds_read_b64_tr_b16 v[106:107], v11 offset:16896
    v_mfma_f32_16x16x32_bf16 v[20:23], v[128:131], v[112:115], v[20:23]
    ds_read_b128 v[76:79], v8 offset:0
    ds_read_b128 v[80:83], v8 offset:2048
    s_add_u32 m0, s37, 4096
    s_nop 0
    buffer_load_dwordx4 v3, s[4:7], s31 offen lds
    v_mfma_f32_16x16x32_bf16 v[40:43], v[132:135], v[112:115], v[40:43]
    ds_read_b128 v[84:87], v8 offset:4096
    ds_read_b128 v[88:91], v8 offset:6144
    v_mfma_f32_16x16x32_bf16 v[60:63], v[136:139], v[112:115], v[60:63]
    ds_read_b128 v[92:95], v8 offset:8192
    v_mfma_f32_16x16x32_bf16 v[24:27], v[128:131], v[116:119], v[24:27]
    s_add_u32 m0, s38, 0
    s_mov_b64 exec, s[60:61]
    buffer_load_dwordx4 v3, s[4:7], s36 offen lds
    s_mov_b64 exec, -1
    v_mfma_f32_16x16x32_bf16 v[44:47], v[132:135], v[116:119], v[44:47]
    v_mfma_f32_16x16x32_bf16 v[64:67], v[136:139], v[116:119], v[64:67]
    v_mfma_f32_16x16x32_bf16 v[28:31], v[128:131], v[120:123], v[28:31]
    s_add_u32 m0, s39, 0
    s_nop 0
    buffer_load_dwordx4 v4, s[12:15], s52 offen lds
    v_mfma_f32_16x16x32_bf16 v[48:51], v[132:135], v[120:123], v[48:51]
    v_mfma_f32_16x16x32_bf16 v[68:71], v[136:139], v[120:123], v[68:71]
    v_mfma_f32_16x16x32_bf16 v[32:35], v[128:131], v[124:127], v[32:35]
    buffer_load_dwordx4 v5, s[12:15], s53 offen offset:1024 lds
    v_mfma_f32_16x16x32_bf16 v[52:55], v[132:135], v[124:127], v[52:55]
    v_mfma_f32_16x16x32_bf16 v[72:75], v[136:139], v[124:127], v[72:75]
    s_waitcnt lgkmcnt(0)
    v_mfma_f32_16x16x32_bf16 v[16:19], v[96:99], v[76:79], v[16:19]
    ds_read_b64_tr_b16 v[128:129], v11 offset:4096
    ds_read_b64_tr_b16 v[130:131], v11 offset:4608
    s_add_u32 m0, s39, 8192
    s_nop 0
    buffer_load_dwordx4 v4, s[12:15], s54 offen lds
    v_mfma_f32_16x16x32_bf16 v[36:39], v[100:103], v[76:79], v[36:39]
    ds_read_b64_tr_b16 v[132:133], v11 offset:12288
    ds_read_b64_tr_b16 v[134:135], v11 offset:12800
    v_mfma_f32_16x16x32_bf16 v[56:59], v[104:107], v[76:79], v[56:59]
    ds_read_b64_tr_b16 v[136:137], v11 offset:20480
    ds_read_b64_tr_b16 v[138:139], v11 offset:20992
    v_mfma_f32_16x16x32_bf16 v[20:23], v[96:99], v[80:83], v[20:23]
    ds_read_b128 v[108:111], v9 offset:0
    ds_read_b128 v[112:115], v9 offset:2048
    buffer_load_dwordx4 v5, s[12:15], s55 offen offset:1024 lds
    v_mfma_f32_16x16x32_bf16 v[40:43], v[100:103], v[80:83], v[40:43]
    ds_read_b128 v[116:119], v9 offset:4096
    ds_read_b128 v[120:123], v9 offset:6144
    v_mfma_f32_16x16x32_bf16 v[60:63], v[104:107], v[80:83], v[60:63]
    ds_read_b128 v[124:127], v9 offset:8192
    v_mfma_f32_16x16x32_bf16 v[24:27], v[96:99], v[84:87], v[24:27]
    v_mfma_f32_16x16x32_bf16 v[44:47], v[100:103], v[84:87], v[44:47]
    s_add_u32 m0, s39, 16384
    s_nop 0
    buffer_load_dwordx4 v4, s[12:15], s56 offen lds
    v_mfma_f32_16x16x32_bf16 v[64:67], v[104:107], v[84:87], v[64:67]
    v_mfma_f32_16x16x32_bf16 v[28:31], v[96:99], v[88:91], v[28:31]
    v_mfma_f32_16x16x32_bf16 v[48:51], v[100:103], v[88:91], v[48:51]
    v_mfma_f32_16x16x32_bf16 v[68:71], v[104:107], v[88:91], v[68:71]
    buffer_load_dwordx4 v5, s[12:15], s57 offen offset:1024 lds
    s_add_u32 s90, s90, 1
    s_and_b32 s90, s90, 7
    s_lshl_b32 s91, s90, 7
    s_mul_i32 s92, s90, 196608
    v_add_u32 v3, s91, v220
    v_add_u32 v4, s92, v221
    v_xor_b32 v5, 64, v4
    v_mfma_f32_16x16x32_bf16 v[32:35], v[96:99], v[92:95], v[32:35]
    v_mfma_f32_16x16x32_bf16 v[52:55], v[100:103], v[92:95], v[52:55]
    v_mfma_f32_16x16x32_bf16 v[72:75], v[104:107], v[92:95], v[72:75]
    s_waitcnt vmcnt(14)
    s_cmp_ge_u32 s3, 224
    s_cbranch_scc1 L_wv_9
    s_waitcnt vmcnt(10)
L_wv_9:
    s_waitcnt lgkmcnt(0)
    ds_write_b32 v149, v239
    s_waitcnt lgkmcnt(0)
    s_barrier
    s_cmp_ge_u32 s3, 224
    s_cbranch_scc1 L_fdone
    v_and_b32 v184, 15, v2
    v_bfe_u32 v185, v2, 4, 1
    v_lshrrev_b32 v186, 5, v2
    v_lshrrev_b32 v187, 2, v184
    v_lshlrev_b32 v187, 7, v187
    v_and_b32 v188, 3, v184
    v_lshl_add_u32 v187, v188, 3, v187
    v_lshlrev_b32 v188, 13, v185
    v_lshl_add_u32 v188, v186, 9, v188
    v_add_u32 v188, v188, v187
    s_lshl_b32 s27, s20, 5
    s_add_u32 s27, s27, 139264
    v_add_u32 v188, s27, v188
    ds_read_b64_tr_b16 v[160:161], v188 offset:0
    ds_read_b64_tr_b16 v[162:163], v188 offset:1024
    ds_read_b64_tr_b16 v[164:165], v188 offset:2048
    ds_read_b64_tr_b16 v[166:167], v188 offset:3072
    ds_read_b64_tr_b16 v[168:169], v188 offset:4096
    ds_read_b64_tr_b16 v[170:171], v188 offset:5120
    ds_read_b64_tr_b16 v[172:173], v188 offset:6144
    ds_read_b64_tr_b16 v[174:175], v188 offset:7168
    s_lshl_b32 s27, s63, 2
    s_add_u32 s27, s27, s20
    s_mov_b32 s87, s27
    s_lshl_b32 s27, s27, 15
    s_lshl_b32 s28, s62, 12
    s_add_u32 s27, s27, s28
    s_add_u32 s88, s27, 0x500000
    v_mov_b32 v190, 0
    s_waitcnt lgkmcnt(0)
    buffer_store_dwordx4 v[160:163], v1, s[8:11], s88 offen offset:0 sc1
    buffer_store_dwordx4 v[164:167], v1, s[8:11], s88 offen offset:1024 sc1
    buffer_store_dwordx4 v[168:171], v1, s[8:11], s88 offen offset:2048 sc1
    buffer_store_dwordx4 v[172:175], v1, s[8:11], s88 offen offset:3072 sc1
    v_dot2c_f32_bf16 v190, v160, v239
    v_dot2c_f32_bf16 v190, v161, v239
    v_dot2c_f32_bf16 v190, v162, v239
    v_dot2c_f32_bf16 v190, v163, v239
    v_dot2c_f32_bf16 v190, v164, v239
    v_dot2c_f32_bf16 v190, v165, v239
    v_dot2c_f32_bf16 v190, v166, v239
    v_dot2c_f32_bf16 v190, v167, v239
    v_dot2c_f32_bf16 v190, v168, v239
    v_dot2c_f32_bf16 v190, v169, v239
    v_dot2c_f32_bf16 v190, v170, v239
    v_dot2c_f32_bf16 v190, v171, v239
    v_dot2c_f32_bf16 v190, v172, v239
    v_dot2c_f32_bf16 v190, v173, v239
    v_dot2c_f32_bf16 v190, v174, v239
    v_dot2c_f32_bf16 v190, v175, v239
    s_nop 2
    v_mov_b32 v187, v190
    s_nop 1
    v_permlane32_swap_b32 v190, v187
    s_nop 0
    v_add_f32 v190, v190, v187
    s_mul_i32 s27, s62, 14336
    s_lshl_b32 s28, s87, 7
    s_add_u32 s27, s27, s28
    s_add_u32 s27, s27, 0x440000
    v_and_b32 v188, 31, v2
    v_lshlrev_b32 v188, 2, v188
    buffer_store_dword v190, v188, s[8:11], s27 offen sc1
L_fdone:
    s_waitcnt lgkmcnt(0)
    v_mfma_f32_16x16x32_bf16 v[16:19], v[128:131], v[108:111], v[16:19]
    ds_read_b64_tr_b16 v[96:97], v11 offset:34816
    ds_read_b64_tr_b16 v[98:99], v11 offset:35328
    s_add_u32 m0, s37, 34816
    s_mov_b64 exec, s[58:59]
    buffer_load_dwordx4 v3, s[4:7], s30 offen lds
    s_mov_b64 exec, -1
    v_mfma_f32_16x16x32_bf16 v[36:39], v[132:135], v[108:111], v[36:39]
    ds_read_b64_tr_b16 v[100:101], v11 offset:43008
    ds_read_b64_tr_b16 v[102:103], v11 offset:43520
    v_mfma_f32_16x16x32_bf16 v[56:59], v[136:139], v[108:111], v[56:59]
    ds_read_b64_tr_b16 v[104:105], v11 offset:51200
    ds_read_b64_tr_b16 v[106:107], v11 offset:51712
    v_mfma_f32_16x16x32_bf16 v[20:23], v[128:131], v[112:115], v[20:23]
    ds_read_b128 v[76:79], v8 offset:34816
    ds_read_b128 v[80:83], v8 offset:36864
    s_add_u32 m0, s37, 38912
    s_nop 0
    buffer_load_dwordx4 v3, s[4:7], s31 offen lds
    v_mfma_f32_16x16x32_bf16 v[40:43], v[132:135], v[112:115], v[40:43]
    ds_read_b128 v[84:87], v8 offset:38912
    ds_read_b128 v[88:91], v8 offset:40960
    v_mfma_f32_16x16x32_bf16 v[60:63], v[136:139], v[112:115], v[60:63]
    ds_read_b128 v[92:95], v8 offset:43008
    v_mfma_f32_16x16x32_bf16 v[24:27], v[128:131], v[116:119], v[24:27]
    s_add_u32 m0, s38, 34816
    s_mov_b64 exec, s[60:61]
    buffer_load_dwordx4 v3, s[4:7], s36 offen lds
    s_mov_b64 exec, -1
    v_mfma_f32_16x16x32_bf16 v[44:47], v[132:135], v[116:119], v[44:47]
    v_mfma_f32_16x16x32_bf16 v[64:67], v[136:139], v[116:119], v[64:67]
    v_mfma_f32_16x16x32_bf16 v[28:31], v[128:131], v[120:123], v[28:31]
    s_add_u32 m0, s39, 34816
    s_nop 0
    buffer_load_dwordx4 v4, s[12:15], s52 offen lds
    v_mfma_f32_16x16x32_bf16 v[48:51], v[132:135], v[120:123], v[48:51]
    v_mfma_f32_16x16x32_bf16 v[68:71], v[136:139], v[120:123], v[68:71]
    v_mfma_f32_16x16x32_bf16 v[32:35], v[128:131], v[124:127], v[32:35]
    buffer_load_dwordx4 v5, s[12:15], s53 offen offset:1024 lds
    v_mfma_f32_16x16x32_bf16 v[52:55], v[132:135], v[124:127], v[52:55]
    v_mfma_f32_16x16x32_bf16 v[72:75], v[136:139], v[124:127], v[72:75]
    s_waitcnt lgkmcnt(0)
    v_mfma_f32_16x16x32_bf16 v[16:19], v[96:99], v[76:79], v[16:19]
    ds_read_b64_tr_b16 v[128:129], v11 offset:38912
    ds_read_b64_tr_b16 v[130:131], v11 offset:39424
    s_add_u32 m0, s39, 43008
    s_nop 0
    buffer_load_dwordx4 v4, s[12:15], s54 offen lds
    v_mfma_f32_16x16x32_bf16 v[36:39], v[100:103], v[76:79], v[36:39]
    ds_read_b64_tr_b16 v[132:133], v11 offset:47104
    ds_read_b64_tr_b16 v[134:135], v11 offset:47616
    v_mfma_f32_16x16x32_bf16 v[56:59], v[104:107], v[76:79], v[56:59]
    ds_read_b64_tr_b16 v[136:137], v11 offset:55296
    ds_read_b64_tr_b16 v[138:139], v11 offset:55808
    v_mfma_f32_16x16x32_bf16 v[20:23], v[96:99], v[80:83], v[20:23]
    ds_read_b128 v[108:111], v9 offset:34816
    ds_read_b128 v[112:115], v9 offset:36864
    buffer_load_dwordx4 v5, s[12:15], s55 offen offset:1024 lds
    v_mfma_f32_16x16x32_bf16 v[40:43], v[100:103], v[80:83], v[40:43]
    ds_read_b128 v[116:119], v9 offset:38912
    ds_read_b128 v[120:123], v9 offset:40960
    v_mfma_f32_16x16x32_bf16 v[60:63], v[104:107], v[80:83], v[60:63]
    ds_read_b128 v[124:127], v9 offset:43008
    v_mfma_f32_16x16x32_bf16 v[24:27], v[96:99], v[84:87], v[24:27]
    v_mfma_f32_16x16x32_bf16 v[44:47], v[100:103], v[84:87], v[44:47]
    s_add_u32 m0, s39, 51200
    s_nop 0
    buffer_load_dwordx4 v4, s[12:15], s56 offen lds
    v_mfma_f32_16x16x32_bf16 v[64:67], v[104:107], v[84:87], v[64:67]
    v_mfma_f32_16x16x32_bf16 v[28:31], v[96:99], v[88:91], v[28:31]
    v_mfma_f32_16x16x32_bf16 v[48:51], v[100:103], v[88:91], v[48:51]
    v_mfma_f32_16x16x32_bf16 v[68:71], v[104:107], v[88:91], v[68:71]
    buffer_load_dwordx4 v5, s[12:15], s57 offen offset:1024 lds
    s_add_u32 s90, s90, 1
    s_and_b32 s90, s90, 7
    s_lshl_b32 s91, s90, 7
    s_mul_i32 s92, s90, 196608
    v_add_u32 v3, s91, v220
    v_add_u32 v4, s92, v221
    v_xor_b32 v5, 64, v4
    v_mfma_f32_16x16x32_bf16 v[32:35], v[96:99], v[92:95], v[32:35]
    v_mfma_f32_16x16x32_bf16 v[52:55], v[100:103], v[92:95], v[52:55]
    v_mfma_f32_16x16x32_bf16 v[72:75], v[104:107], v[92:95], v[72:75]
    s_waitcnt vmcnt(14)
    s_cmp_lt_u32 s3, 224
    s_cbranch_scc1 L_wv_10
    s_waitcnt vmcnt(9)
L_wv_10:
    s_waitcnt lgkmcnt(0)
    s_barrier
    s_waitcnt lgkmcnt(0)
    v_mfma_f32_16x16x32_bf16 v[16:19], v[128:131], v[108:111], v[16:19]
    ds_read_b64_tr_b16 v[96:97], v10 offset:0
    ds_read_b64_tr_b16 v[98:99], v10 offset:512
    s_add_u32 m0, s37, 69632
    s_mov_b64 exec, s[58:59]
    buffer_load_dwordx4 v3, s[4:7], s30 offen lds
    s_mov_b64 exec, -1
    v_mfma_f32_16x16x32_bf16 v[36:39], v[132:135], v[108:111], v[36:39]
    ds_read_b64_tr_b16 v[100:101], v10 offset:8192
    ds_read_b64_tr_b16 v[102:103], v10 offset:8704
    v_mfma_f32_16x16x32_bf16 v[56:59], v[136:139], v[108:111], v[56:59]
    ds_read_b64_tr_b16 v[104:105], v10 offset:16384
    ds_read_b64_tr_b16 v[106:107], v10 offset:16896
    s_add_u32 m0, s37, 73728
    s_nop 0
    buffer_load_dwordx4 v3, s[4:7], s31 offen lds
    v_mfma_f32_16x16x32_bf16 v[20:23], v[128:131], v[112:115], v[20:23]
    ds_read_b128 v[76:79], v6 offset:0
    ds_read_b128 v[80:83], v6 offset:2048
    v_mfma_f32_16x16x32_bf16 v[40:43], v[132:135], v[112:115], v[40:43]
    ds_read_b128 v[84:87], v6 offset:4096
    ds_read_b128 v[88:91], v6 offset:6144
    v_mfma_f32_16x16x32_bf16 v[60:63], v[136:139], v[112:115], v[60:63]
    ds_read_b128 v[92:95], v6 offset:8192
    s_add_u32 m0, s38, 69632
    s_mov_b64 exec, s[60:61]
    buffer_load_dwordx4 v3, s[4:7], s36 offen lds
    s_mov_b64 exec, -1
    v_mfma_f32_16x16x32_bf16 v[24:27], v[128:131], v[116:119], v[24:27]
    v_mfma_f32_16x16x32_bf16 v[44:47], v[132:135], v[116:119], v[44:47]
    s_add_u32 m0, s39, 69632
    s_nop 0
    buffer_load_dwordx4 v4, s[12:15], s52 offen lds
    v_mfma_f32_16x16x32_bf16 v[64:67], v[136:139], v[116:119], v[64:67]
    v_mfma_f32_16x16x32_bf16 v[28:31], v[128:131], v[120:123], v[28:31]
    v_mfma_f32_16x16x32_bf16 v[48:51], v[132:135], v[120:123], v[48:51]
    buffer_load_dwordx4 v5, s[12:15], s53 offen offset:1024 lds
    v_mfma_f32_16x16x32_bf16 v[68:71], v[136:139], v[120:123], v[68:71]
    v_mfma_f32_16x16x32_bf16 v[32:35], v[128:131], v[124:127], v[32:35]
    s_cmp_lg_u32 s20, 0
    s_cbranch_scc1 L_pa_11
    s_cmp_lt_u32 s3, 224
    s_cbranch_scc1 L_pa_11
    s_sub_u32 s80, s3, 224
    s_lshr_b32 s81, s80, 2
    s_lshl_b32 s81, s81, 7
    s_and_b32 s80, s80, 3
    s_add_u32 s80, s80, 28
    s_lshl_b32 s80, s80, 2
    s_add_u32 s80, s80, s81
    s_add_u32 s82, s80, 0x1303000
    v_mov_b32 v184, s23
    v_mov_b32 v185, 0
    s_mov_b64 exec, 1
    buffer_store_dword v184, v185, s[8:11], s82 offen sc1
    s_mov_b64 exec, -1
L_pa_11:
    v_mfma_f32_16x16x32_bf16 v[52:55], v[132:135], v[124:127], v[52:55]
    v_mfma_f32_16x16x32_bf16 v[72:75], v[136:139], v[124:127], v[72:75]
    s_waitcnt lgkmcnt(0)
    v_mfma_f32_16x16x32_bf16 v[16:19], v[96:99], v[76:79], v[16:19]
    ds_read_b64_tr_b16 v[128:129], v10 offset:4096
    ds_read_b64_tr_b16 v[130:131], v10 offset:4608
    s_add_u32 m0, s39, 77824
    s_nop 0
    buffer_load_dwordx4 v4, s[12:15], s54 offen lds
    v_mfma_f32_16x16x32_bf16 v[36:39], v[100:103], v[76:79], v[36:39]
    ds_read_b64_tr_b16 v[132:133], v10 offset:12288
    ds_read_b64_tr_b16 v[134:135], v10 offset:12800
    v_mfma_f32_16x16x32_bf16 v[56:59], v[104:107], v[76:79], v[56:59]
    ds_read_b64_tr_b16 v[136:137], v10 offset:20480
    ds_read_b64_tr_b16 v[138:139], v10 offset:20992
    v_mfma_f32_16x16x32_bf16 v[20:23], v[96:99], v[80:83], v[20:23]
    ds_read_b128 v[108:111], v7 offset:0
    ds_read_b128 v[112:115], v7 offset:2048
    buffer_load_dwordx4 v5, s[12:15], s55 offen offset:1024 lds
    v_mfma_f32_16x16x32_bf16 v[40:43], v[100:103], v[80:83], v[40:43]
    ds_read_b128 v[116:119], v7 offset:4096
    ds_read_b128 v[120:123], v7 offset:6144
    v_mfma_f32_16x16x32_bf16 v[60:63], v[104:107], v[80:83], v[60:63]
    ds_read_b128 v[124:127], v7 offset:8192
    v_mfma_f32_16x16x32_bf16 v[24:27], v[96:99], v[84:87], v[24:27]
    v_mfma_f32_16x16x32_bf16 v[44:47], v[100:103], v[84:87], v[44:47]
    s_add_u32 m0, s39, 86016
    s_nop 0
    buffer_load_dwordx4 v4, s[12:15], s56 offen lds
    v_mfma_f32_16x16x32_bf16 v[64:67], v[104:107], v[84:87], v[64:67]
    v_mfma_f32_16x16x32_bf16 v[28:31], v[96:99], v[88:91], v[28:31]
    v_mfma_f32_16x16x32_bf16 v[48:51], v[100:103], v[88:91], v[48:51]
    v_mfma_f32_16x16x32_bf16 v[68:71], v[104:107], v[88:91], v[68:71]
    buffer_load_dwordx4 v5, s[12:15], s57 offen offset:1024 lds
    s_add_u32 s90, s90, 1
    s_and_b32 s90, s90, 7
    s_lshl_b32 s91, s90, 7
    s_mul_i32 s92, s90, 196608
    v_add_u32 v3, s91, v220
    v_add_u32 v4, s92, v221
    v_xor_b32 v5, 64, v4
    v_mfma_f32_16x16x32_bf16 v[32:35], v[96:99], v[92:95], v[32:35]
    v_mfma_f32_16x16x32_bf16 v[52:55], v[100:103], v[92:95], v[52:55]
    v_mfma_f32_16x16x32_bf16 v[72:75], v[104:107], v[92:95], v[72:75]
    s_waitcnt vmcnt(9) lgkmcnt(0)
    s_barrier
    s_cmp_ge_u32 s3, 224
    s_cbranch_scc1 L_pdd
    v_lshrrev_b32 v14, 3, v2
    v_and_b32 v15, 7, v2
    v_lshlrev_b32 v15, 4, v15
    v_lshl_add_u32 v13, v14, 10, v15
    s_mov_b32 s68, s48
    s_and_b32 s69, s49, 0xffff
    s_mov_b32 s70, 0x1c0000
    s_mov_b32 s71, 0x20000
    s_lshl_b32 s82, s63, 6
    s_lshl_b32 s28, s20, 4
    s_add_u32 s82, s82, s28
    s_lshl_b32 s82, s82, 10
    s_lshl_b32 s28, s62, 7
    s_add_u32 s82, s82, s28
    s_add_u32 s83, s82, 7168
    s_lshl_b32 s27, s20, 11
    s_add_u32 m0, s27, 155648
    s_nop 0
    buffer_load_dwordx4 v13, s[68:71], s82 offen nt lds
    buffer_load_dwordx4 v13, s[68:71], s83 offen offset:1024 nt lds
L_pdd:
    s_cmp_lg_u32 s20, 0
    s_cbranch_scc1 L_pb_12
    s_cmp_ge_u32 s3, 224
    s_cbranch_scc1 L_pb_12
    s_lshl_b32 s80, s63, 2
    s_add_u32 s80, s80, 0
    s_mul_i32 s80, s80, 9363
    s_lshr_b32 s80, s80, 16
    s_mul_i32 s81, s80, 7
    s_lshr_b32 s81, s81, 2
    s_sub_u32 s81, s63, s81
    s_lshl_b32 s81, s81, 3
    s_add_u32 s81, s81, s62
    s_lshl_b32 s81, s81, 2
    s_lshl_b32 s80, s80, 7
    s_add_u32 s80, s80, s81
    s_add_u32 s82, s80, 0x1302000
    s_lshl_b32 s80, s63, 2
    s_add_u32 s80, s80, 3
    s_mul_i32 s80, s80, 9363
    s_lshr_b32 s80, s80, 16
    s_mul_i32 s81, s80, 7
    s_lshr_b32 s81, s81, 2
    s_sub_u32 s81, s63, s81
    s_lshl_b32 s81, s81, 3
    s_add_u32 s81, s81, s62
    s_lshl_b32 s81, s81, 2
    s_lshl_b32 s80, s80, 7
    s_add_u32 s80, s80, s81
    s_add_u32 s83, s80, 0x1302000
    s_lshl_b32 s80, s62, 7
    s_lshl_b32 s81, s63, 2
    s_add_u32 s80, s80, s81
    s_add_u32 s86, s80, 0x1303000
    v_mov_b32 v185, s82
    v_writelane_b32 v185, s83, 1
    v_mov_b32 v184, s23
    s_mov_b64 exec, 3
    buffer_store_dword v184, v185, s[8:11], 0 offen sc1
    s_mov_b64 exec, -1
L_pb_12:
    s_waitcnt lgkmcnt(0)
    v_mfma_f32_16x16x32_bf16 v[16:19], v[128:131], v[108:111], v[16:19]
    ds_read_b64_tr_b16 v[96:97], v10 offset:34816
    ds_read_b64_tr_b16 v[98:99], v10 offset:35328
    s_cmp_lg_u32 s20, 0
    s_cbranch_scc1 L_xl_13
    v_and_b32 v194, 15, v2
    v_lshlrev_b32 v194, 2, v194
    s_lshl_b32 s95, s21, 7
    s_add_u32 s95, s95, 0x1304000
    buffer_load_dword v192, v194, s[8:11], s95 offen sc1
L_xl_13:
    v_mfma_f32_16x16x32_bf16 v[36:39], v[132:135], v[108:111], v[36:39]
    ds_read_b64_tr_b16 v[100:101], v10 offset:43008
    ds_read_b64_tr_b16 v[102:103], v10 offset:43520
    v_mfma_f32_16x16x32_bf16 v[56:59], v[136:139], v[108:111], v[56:59]
    ds_read_b64_tr_b16 v[104:105], v10 offset:51200
    ds_read_b64_tr_b16 v[106:107], v10 offset:51712
    s_add_u32 m0, s37, 104448
    s_mov_b64 exec, s[58:59]
    buffer_load_dwordx4 v3, s[4:7], s30 offen lds
    s_mov_b64 exec, -1
    v_mfma_f32_16x16x32_bf16 v[20:23], v[128:131], v[112:115], v[20:23]
    ds_read_b128 v[76:79], v6 offset:34816
    ds_read_b128 v[80:83], v6 offset:36864
    v_mfma_f32_16x16x32_bf16 v[40:43], v[132:135], v[112:115], v[40:43]
    ds_read_b128 v[84:87], v6 offset:38912
    ds_read_b128 v[88:91], v6 offset:40960
    v_mfma_f32_16x16x32_bf16 v[60:63], v[136:139], v[112:115], v[60:63]
    ds_read_b128 v[92:95], v6 offset:43008
    s_add_u32 m0, s37, 108544
    s_nop 0
    buffer_load_dwordx4 v3, s[4:7], s31 offen lds
    v_mfma_f32_16x16x32_bf16 v[24:27], v[128:131], v[116:119], v[24:27]
    v_mfma_f32_16x16x32_bf16 v[44:47], v[132:135], v[116:119], v[44:47]
    s_add_u32 m0, s38, 104448
    s_mov_b64 exec, s[60:61]
    buffer_load_dwordx4 v3, s[4:7], s36 offen lds
    s_mov_b64 exec, -1
    v_mfma_f32_16x16x32_bf16 v[64:67], v[136:139], v[116:119], v[64:67]
    v_mfma_f32_16x16x32_bf16 v[28:31], v[128:131], v[120:123], v[28:31]
    v_mfma_f32_16x16x32_bf16 v[48:51], v[132:135], v[120:123], v[48:51]
    s_add_u32 m0, s39, 104448
    s_nop 0
    buffer_load_dwordx4 v4, s[12:15], s52 offen lds
    v_mfma_f32_16x16x32_bf16 v[68:71], v[136:139], v[120:123], v[68:71]
    v_mfma_f32_16x16x32_bf16 v[32:35], v[128:131], v[124:127], v[32:35]
    buffer_load_dwordx4 v5, s[12:15], s53 offen offset:1024 lds
    v_mfma_f32_16x16x32_bf16 v[52:55], v[132:135], v[124:127], v[52:55]
    v_mfma_f32_16x16x32_bf16 v[72:75], v[136:139], v[124:127], v[72:75]
    s_waitcnt lgkmcnt(0)
    v_mfma_f32_16x16x32_bf16 v[16:19], v[96:99], v[76:79], v[16:19]
    ds_read_b64_tr_b16 v[128:129], v10 offset:38912
    ds_read_b64_tr_b16 v[130:131], v10 offset:39424
    s_add_u32 m0, s39, 112640
    s_nop 0
    buffer_load_dwordx4 v4, s[12:15], s54 offen lds
    v_mfma_f32_16x16x32_bf16 v[36:39], v[100:103], v[76:79], v[36:39]
    ds_read_b64_tr_b16 v[132:133], v10 offset:47104
    ds_read_b64_tr_b16 v[134:135], v10 offset:47616
    v_mfma_f32_16x16x32_bf16 v[56:59], v[104:107], v[76:79], v[56:59]
    ds_read_b64_tr_b16 v[136:137], v10 offset:55296
    ds_read_b64_tr_b16 v[138:139], v10 offset:55808
    v_mfma_f32_16x16x32_bf16 v[20:23], v[96:99], v[80:83], v[20:23]
    ds_read_b128 v[108:111], v7 offset:34816
    ds_read_b128 v[112:115], v7 offset:36864
    buffer_load_dwordx4 v5, s[12:15], s55 offen offset:1024 lds
    v_mfma_f32_16x16x32_bf16 v[40:43], v[100:103], v[80:83], v[40:43]
    ds_read_b128 v[116:119], v7 offset:38912
    ds_read_b128 v[120:123], v7 offset:40960
    v_mfma_f32_16x16x32_bf16 v[60:63], v[104:107], v[80:83], v[60:63]
    ds_read_b128 v[124:127], v7 offset:43008
    v_mfma_f32_16x16x32_bf16 v[24:27], v[96:99], v[84:87], v[24:27]
    v_mfma_f32_16x16x32_bf16 v[44:47], v[100:103], v[84:87], v[44:47]
    s_add_u32 m0, s39, 120832
    s_nop 0
    buffer_load_dwordx4 v4, s[12:15], s56 offen lds
    v_mfma_f32_16x16x32_bf16 v[64:67], v[104:107], v[84:87], v[64:67]
    v_mfma_f32_16x16x32_bf16 v[28:31], v[96:99], v[88:91], v[28:31]
    v_mfma_f32_16x16x32_bf16 v[48:51], v[100:103], v[88:91], v[48:51]
    v_mfma_f32_16x16x32_bf16 v[68:71], v[104:107], v[88:91], v[68:71]
    buffer_load_dwordx4 v5, s[12:15], s57 offen offset:1024 lds
    s_add_u32 s90, s90, 1
    s_and_b32 s90, s90, 7
    s_lshl_b32 s91, s90, 7
    s_mul_i32 s92, s90, 196608
    v_add_u32 v3, s91, v220
    v_add_u32 v4, s92, v221
    v_xor_b32 v5, 64, v4
    v_mfma_f32_16x16x32_bf16 v[32:35], v[96:99], v[92:95], v[32:35]
    v_mfma_f32_16x16x32_bf16 v[52:55], v[100:103], v[92:95], v[52:55]
    v_mfma_f32_16x16x32_bf16 v[72:75], v[104:107], v[92:95], v[72:75]
    s_waitcnt vmcnt(11)
    s_cmp_lt_u32 s3, 224
    s_cbranch_scc1 L_wv_14
    s_waitcnt vmcnt(9)
L_wv_14:
    s_waitcnt lgkmcnt(0)
    s_barrier
    v_and_b32 v12, 15, v2
    v_lshlrev_b32 v12, 4, v12
    s_lshl_b32 s27, s26, 10
    s_add_u32 s28, s27, 0x1310000
    s_sub_u32 s27, s28, 256
    s_cmp_eq_u32 s26, 0
    s_cselect_b32 s84, s28, s27
    s_mov_b32 s85, s28
    buffer_load_dwordx4 v[200:203], v12, s[8:11], s84 offen sc1
    buffer_load_dwordx4 v[204:207], v12, s[8:11], s85 offen offset:0 sc1
    buffer_load_dwordx4 v[208:211], v12, s[8:11], s85 offen offset:256 sc1
    buffer_load_dwordx4 v[212:215], v12, s[8:11], s85 offen offset:512 sc1
    buffer_load_dwordx4 v[216:219], v12, s[8:11], s85 offen offset:768 sc1
    s_waitcnt lgkmcnt(0)
    v_mfma_f32_16x16x32_bf16 v[16:19], v[128:131], v[108:111], v[16:19]
    ds_read_b64_tr_b16 v[96:97], v11 offset:0
    ds_read_b64_tr_b16 v[98:99], v11 offset:512
    s_lshl_b32 s82, s26, 16
    s_lshl_b32 s83, s25, 12
    s_add_u32 s82, s82, s83
    s_lshl_b32 s83, s20, 10
    s_add_u32 s82, s82, s83
    s_add_u32 s82, s82, 0x0
    buffer_load_dwordx4 v[228:231], v1, s[8:11], s82 offen sc1
    v_mfma_f32_16x16x32_bf16 v[36:39], v[132:135], v[108:111], v[36:39]
    ds_read_b64_tr_b16 v[100:101], v11 offset:8192
    ds_read_b64_tr_b16 v[102:103], v11 offset:8704
    v_mfma_f32_16x16x32_bf16 v[56:59], v[136:139], v[108:111], v[56:59]
    ds_read_b64_tr_b16 v[104:105], v11 offset:16384
    ds_read_b64_tr_b16 v[106:107], v11 offset:16896
    v_mfma_f32_16x16x32_bf16 v[20:23], v[128:131], v[112:115], v[20:23]
    ds_read_b128 v[76:79], v8 offset:0
    ds_read_b128 v[80:83], v8 offset:2048
    s_add_u32 s82, s82, 32768
    buffer_load_dwordx4 v[228:231], v1, s[8:11], s82 offen sc1
    v_mfma_f32_16x16x32_bf16 v[40:43], v[132:135], v[112:115], v[40:43]
    ds_read_b128 v[84:87], v8 offset:4096
    ds_read_b128 v[88:91], v8 offset:6144
    v_mfma_f32_16x16x32_bf16 v[60:63], v[136:139], v[112:115], v[60:63]
    ds_read_b128 v[92:95], v8 offset:8192
    v_mfma_f32_16x16x32_bf16 v[24:27], v[128:131], v[116:119], v[24:27]
    s_lshr_b32 s82, s20, 1
    s_lshl_b32 s83, s26, 1
    s_add_u32 s82, s82, s83
    s_lshl_b32 s82, s82, 15
    s_and_b32 s83, s20, 1
    s_lshl_b32 s83, s83, 11
    s_add_u32 s82, s82, s83
    s_lshl_b32 s83, s25, 12
    s_add_u32 s82, s82, s83
    s_add_u32 s82, s82, 0x200000
    buffer_load_dwordx4 v[228:231], v1, s[8:11], s82 offen sc1
    v_mfma_f32_16x16x32_bf16 v[44:47], v[132:135], v[116:119], v[44:47]
    v_mfma_f32_16x16x32_bf16 v[64:67], v[136:139], v[116:119], v[64:67]
    v_mfma_f32_16x16x32_bf16 v[28:31], v[128:131], v[120:123], v[28:31]
    buffer_load_dwordx4 v[228:231], v1, s[8:11], s82 offen offset:1024 sc1
    v_mfma_f32_16x16x32_bf16 v[48:51], v[132:135], v[120:123], v[48:51]
    v_mfma_f32_16x16x32_bf16 v[68:71], v[136:139], v[120:123], v[68:71]
    v_mfma_f32_16x16x32_bf16 v[32:35], v[128:131], v[124:127], v[32:35]
    s_lshr_b32 s82, s20, 1
    s_lshl_b32 s83, s26, 1
    s_add_u32 s82, s82, s83
    s_lshl_b32 s82, s82, 12
    s_and_b32 s83, s25, 3
    s_lshl_b32 s83, s83, 10
    s_add_u32 s82, s82, s83
    s_lshr_b32 s83, s25, 2
    s_lshl_b32 s83, s83, 9
    s_add_u32 s82, s82, s83
    s_add_u32 s82, s82, 0x400000
    v_lshlrev_b32 v232, 3, v2
    buffer_load_dwordx2 v[228:229], v232, s[8:11], s82 offen sc1
    v_mfma_f32_16x16x32_bf16 v[52:55], v[132:135], v[124:127], v[52:55]
    v_mfma_f32_16x16x32_bf16 v[72:75], v[136:139], v[124:127], v[72:75]
    s_waitcnt lgkmcnt(0)
    v_mfma_f32_16x16x32_bf16 v[16:19], v[96:99], v[76:79], v[16:19]
    ds_read_b64_tr_b16 v[128:129], v11 offset:4096
    ds_read_b64_tr_b16 v[130:131], v11 offset:4608
    v_mfma_f32_16x16x32_bf16 v[36:39], v[100:103], v[76:79], v[36:39]
    ds_read_b64_tr_b16 v[132:133], v11 offset:12288
    ds_read_b64_tr_b16 v[134:135], v11 offset:12800
    v_mfma_f32_16x16x32_bf16 v[56:59], v[104:107], v[76:79], v[56:59]
    ds_read_b64_tr_b16 v[136:137], v11 offset:20480
    ds_read_b64_tr_b16 v[138:139], v11 offset:20992
    v_mfma_f32_16x16x32_bf16 v[20:23], v[96:99], v[80:83], v[20:23]
    ds_read_b128 v[108:111], v9 offset:0
    ds_read_b128 v[112:115], v9 offset:2048
    v_mfma_f32_16x16x32_bf16 v[40:43], v[100:103], v[80:83], v[40:43]
    ds_read_b128 v[116:119], v9 offset:4096
    ds_read_b128 v[120:123], v9 offset:6144
    v_mfma_f32_16x16x32_bf16 v[60:63], v[104:107], v[80:83], v[60:63]
    ds_read_b128 v[124:127], v9 offset:8192
    v_mfma_f32_16x16x32_bf16 v[24:27], v[96:99], v[84:87], v[24:27]
    v_mfma_f32_16x16x32_bf16 v[44:47], v[100:103], v[84:87], v[44:47]
    v_mfma_f32_16x16x32_bf16 v[64:67], v[104:107], v[84:87], v[64:67]
    v_mfma_f32_16x16x32_bf16 v[28:31], v[96:99], v[88:91], v[28:31]
    v_mfma_f32_16x16x32_bf16 v[48:51], v[100:103], v[88:91], v[48:51]
    v_mfma_f32_16x16x32_bf16 v[68:71], v[104:107], v[88:91], v[68:71]
    v_mfma_f32_16x16x32_bf16 v[32:35], v[96:99], v[92:95], v[32:35]
    v_mfma_f32_16x16x32_bf16 v[52:55], v[100:103], v[92:95], v[52:55]
    v_mfma_f32_16x16x32_bf16 v[72:75], v[104:107], v[92:95], v[72:75]
    s_waitcnt vmcnt(10) lgkmcnt(0)
    s_cmp_lg_u32 s20, 0
    s_cbranch_scc1 L_xs_17
    s_mov_b32 s29, 0
L_xp_15:
    v_subrev_u32 v193, s23, v192
    v_cmp_lt_u32 vcc, 15, v193
    s_cbranch_vccz L_xd_16
    s_add_u32 s29, s29, 1
    s_cmp_ge_u32 s29, 32768
    s_cbranch_scc1 L_xd_16
    buffer_load_dword v192, v194, s[8:11], s95 offen sc1
    s_waitcnt vmcnt(0)
    s_branch L_xp_15
L_xd_16:
    v_cmp_ne_u32 vcc, s93, v193
    s_mov_b32 s94, 0
    s_cbranch_vccnz L_xd_16_n
    s_mov_b32 s94, 1
L_xd_16_n:
    v_mov_b32 v193, s94
    v_mov_b32 v194, 1024
    ds_write_b32 v194, v193
    s_waitcnt lgkmcnt(0)
L_xs_17:
    s_barrier
    s_cmp_ge_u32 s3, 224
    s_cbranch_scc1 L_ddone
    v_and_b32 v184, 15, v2
    v_bfe_u32 v185, v2, 4, 1
    v_lshrrev_b32 v186, 5, v2
    v_lshrrev_b32 v187, 2, v184
    v_lshlrev_b32 v187, 7, v187
    v_and_b32 v188, 3, v184
    v_lshl_add_u32 v187, v188, 3, v187
    v_lshlrev_b32 v189, 5, v185
    v_lshl_add_u32 v189, v186, 9, v189
    v_add_u32 v189, v189, v187
    s_and_b32 s27, s20, 1
    s_lshl_b32 s27, s27, 6
    s_lshr_b32 s28, s20, 1
    s_lshl_b32 s28, s28, 12
    s_add_u32 s27, s27, s28
    s_add_u32 s27, s27, 155648
    v_add_u32 v189, s27, v189
    ds_read_b64_tr_b16 v[160:161], v189 offset:0
    ds_read_b64_tr_b16 v[162:163], v189 offset:1024
    ds_read_b64_tr_b16 v[164:165], v189 offset:2048
    ds_read_b64_tr_b16 v[166:167], v189 offset:3072
    s_lshl_b32 s27, s62, 1
    s_and_b32 s28, s20, 1
    s_add_u32 s27, s27, s28
    s_mul_i32 s27, s27, 114688
    s_lshl_b32 s28, s63, 12
    s_add_u32 s27, s27, s28
    s_lshr_b32 s28, s20, 1
    s_lshl_b32 s28, s28, 11
    s_add_u32 s27, s27, s28
    s_add_u32 s89, s27, 0x880000
    s_waitcnt lgkmcnt(0)
    buffer_store_dwordx4 v[160:163], v1, s[8:11], s89 offen offset:0 sc1
    buffer_store_dwordx4 v[164:167], v1, s[8:11], s89 offen offset:1024 sc1
L_ddone:
    v_mov_b32 v194, 1024
    ds_read_b32 v193, v194
    s_mov_b32 s72, s8
    s_mov_b32 s73, s9
    s_mov_b32 s75, 0x20000
    s_mov_b32 s76, s8
    s_mov_b32 s77, s9
    s_mov_b32 s79, 0x20000
    s_waitcnt lgkmcnt(0)
    v_readfirstlane_b32 s94, v193
    s_nop 0
    s_cmp_eq_u32 s94, 1
    s_cselect_b32 s74, 0, s10
    s_cselect_b32 s78, s10, 0
    s_waitcnt lgkmcnt(0)
    v_mfma_f32_16x16x32_bf16 v[16:19], v[128:131], v[108:111], v[16:19]
    ds_read_b64_tr_b16 v[96:97], v11 offset:34816
    ds_read_b64_tr_b16 v[98:99], v11 offset:35328
    s_cmp_lg_u32 s20, 0
    s_cbranch_scc1 L_pl_18
    s_mul_i32 s80, s22, 7
    s_add_u32 s81, s80, 6
    s_lshr_b32 s81, s81, 2
    s_lshr_b32 s80, s80, 2
    s_sub_u32 s81, s81, s80
    s_lshl_b32 s81, s81, 3
    s_add_u32 s81, s81, 7
    v_and_b32 v197, 31, v2
    v_min_u32 v196, s81, v197
    s_lshl_b32 s80, s22, 7
    s_add_u32 s80, s80, 0x1302000
    v_lshl_add_u32 v196, v196, 2, s80
    s_lshl_b32 s80, s25, 7
    s_add_u32 s80, s80, 0x1303070
    v_and_b32 v197, 3, v197
    v_lshl_add_u32 v197, v197, 2, s80
    v_cmp_lt_u32 vcc, 31, v2
    s_nop 1
    v_cndmask_b32 v197, v197, v196, vcc
    buffer_load_dword v196, v197, s[8:11], 0 offen sc1
L_pl_18:
    v_mfma_f32_16x16x32_bf16 v[36:39], v[132:135], v[108:111], v[36:39]
    ds_read_b64_tr_b16 v[100:101], v11 offset:43008
    ds_read_b64_tr_b16 v[102:103], v11 offset:43520
    v_and_b32 v12, 15, v2
    v_lshrrev_b32 v13, 4, v2
    v_lshlrev_b32 v14, 2, v13
    v_sub_u32 v14, v12, v14
    v_mfma_f32_16x16x32_bf16 v[56:59], v[136:139], v[108:111], v[56:59]
    ds_read_b64_tr_b16 v[104:105], v11 offset:51200
    ds_read_b64_tr_b16 v[106:107], v11 offset:51712
    v_mov_b32 v15, 0x3f80
    v_cmp_eq_u32 vcc, 0, v14
    v_mov_b32 v199, 0x3f800000
    s_nop 0
    v_cndmask_b32 v198, 0, v15, vcc
    v_mfma_f32_16x16x32_bf16 v[20:23], v[128:131], v[112:115], v[20:23]
    ds_read_b128 v[76:79], v8 offset:34816
    ds_read_b128 v[80:83], v8 offset:36864
    v_mfma_f32_16x16x32_bf16 v[40:43], v[132:135], v[112:115], v[40:43]
    ds_read_b128 v[84:87], v8 offset:38912
    ds_read_b128 v[88:91], v8 offset:40960
    v_cmp_eq_u32 vcc, 1, v14
    s_nop 1
    v_cndmask_b32 v198, v198, v199, vcc
    v_mfma_f32_16x16x32_bf16 v[60:63], v[136:139], v[112:115], v[60:63]
    ds_read_b128 v[92:95], v8 offset:43008
    v_cmp_eq_u32 vcc, 3, v14
    s_nop 1
    v_cndmask_b32 v199, 0, v199, vcc
    v_mfma_f32_16x16x32_bf16 v[24:27], v[128:131], v[116:119], v[24:27]
    v_cmp_eq_u32 vcc, 2, v14
    s_nop 1
    v_cndmask_b32 v199, v199, v15, vcc
    v_mfma_f32_16x16x32_bf16 v[44:47], v[132:135], v[116:119], v[44:47]
    v_mfma_f32_16x16x32_bf16 v[64:67], v[136:139], v[116:119], v[64:67]
    v_and_b32 v15, 1, v12
    v_cmp_eq_u32 s[88:89], 1, v15
    v_mfma_f32_16x16x32_bf16 v[28:31], v[128:131], v[120:123], v[28:31]
    v_lshl_add_u32 v14, v13, 2, v15
    v_cmp_le_u32 s[82:83], v14, v12
    v_mfma_f32_16x16x32_bf16 v[48:51], v[132:135], v[120:123], v[48:51]
    v_add_u32 v14, 2, v14
    v_cmp_le_u32 s[90:91], v14, v12
    v_lshlrev_b32 v15, 4, v15
    v_mfma_f32_16x16x32_bf16 v[68:71], v[136:139], v[120:123], v[68:71]
    v_mfma_f32_16x16x32_bf16 v[32:35], v[128:131], v[124:127], v[32:35]
    v_mov_b32 v14, 0xce6e6b28
    v_mov_b32 v220, v239
    v_mov_b32 v221, v239
    v_mov_b32 v222, v239
    v_mov_b32 v223, v239
    v_mfma_f32_16x16x32_bf16 v[52:55], v[132:135], v[124:127], v[52:55]
    v_lshrrev_b32 v224, 1, v13
    v_lshlrev_b32 v224, 9, v224
    v_lshl_add_u32 v224, v12, 4, v224
    v_and_b32 v13, 1, v13
    v_lshl_add_u32 v224, v13, 3, v224
    v_mfma_f32_16x16x32_bf16 v[72:75], v[136:139], v[124:127], v[72:75]
    s_waitcnt lgkmcnt(0)
    v_mfma_f32_16x16x32_bf16 v[16:19], v[96:99], v[76:79], v[16:19]
    ds_read_b64_tr_b16 v[128:129], v11 offset:38912
    ds_read_b64_tr_b16 v[130:131], v11 offset:39424
    v_mfma_f32_16x16x32_bf16 v[36:39], v[100:103], v[76:79], v[36:39]
    ds_read_b64_tr_b16 v[132:133], v11 offset:47104
    ds_read_b64_tr_b16 v[134:135], v11 offset:47616
    v_mfma_f32_16x16x32_bf16 v[56:59], v[104:107], v[76:79], v[56:59]
    ds_read_b64_tr_b16 v[136:137], v11 offset:55296
    ds_read_b64_tr_b16 v[138:139], v11 offset:55808
    v_mfma_f32_16x16x32_bf16 v[20:23], v[96:99], v[80:83], v[20:23]
    ds_read_b128 v[108:111], v9 offset:34816
    ds_read_b128 v[112:115], v9 offset:36864
    v_mfma_f32_16x16x32_bf16 v[40:43], v[100:103], v[80:83], v[40:43]
    ds_read_b128 v[116:119], v9 offset:38912
    ds_read_b128 v[120:123], v9 offset:40960
    v_mfma_f32_16x16x32_bf16 v[60:63], v[104:107], v[80:83], v[60:63]
    ds_read_b128 v[124:127], v9 offset:43008
    v_mfma_f32_16x16x32_bf16 v[24:27], v[96:99], v[84:87], v[24:27]
    v_mfma_f32_16x16x32_bf16 v[44:47], v[100:103], v[84:87], v[44:47]
    v_mfma_f32_16x16x32_bf16 v[64:67], v[104:107], v[84:87], v[64:67]
    v_mfma_f32_16x16x32_bf16 v[28:31], v[96:99], v[88:91], v[28:31]
    v_mfma_f32_16x16x32_bf16 v[48:51], v[100:103], v[88:91], v[48:51]
    v_mfma_f32_16x16x32_bf16 v[68:71], v[104:107], v[88:91], v[68:71]
    v_mfma_f32_16x16x32_bf16 v[32:35], v[96:99], v[92:95], v[32:35]
    v_mfma_f32_16x16x32_bf16 v[52:55], v[100:103], v[92:95], v[52:55]
    v_mfma_f32_16x16x32_bf16 v[72:75], v[104:107], v[92:95], v[72:75]
    s_waitcnt vmcnt(7)
    s_cmp_lt_u32 s3, 224
    s_cbranch_scc1 L_wv_19
    s_waitcnt vmcnt(5)
L_wv_19:
    s_waitcnt lgkmcnt(0)
    s_cmp_lg_u32 s20, 0
    s_cbranch_scc1 L_cs_22
    s_mov_b32 s29, 0
    s_waitcnt vmcnt(0)
L_cp_20:
    v_cmp_ne_u32 vcc, s23, v196
    s_cbranch_vccz L_cd_21
    s_add_u32 s29, s29, 1
    s_cmp_ge_u32 s29, 32768
    s_cbranch_scc1 L_cd_21
    buffer_load_dword v196, v197, s[8:11], 0 offen sc1
    s_waitcnt vmcnt(0)
    s_branch L_cp_20
L_cd_21:
L_cs_22:
    s_barrier
    s_waitcnt lgkmcnt(0)
    v_mfma_f32_16x16x32_bf16 v[16:19], v[128:131], v[108:111], v[16:19]
    s_and_b32 s27, s20, 1
    s_lshl_b32 s30, s25, 1
    s_add_u32 s30, s30, s27
    s_lshr_b32 s27, s20, 1
    v_mfma_f32_16x16x32_bf16 v[36:39], v[132:135], v[108:111], v[36:39]
    s_lshl_b32 s31, s26, 1
    s_add_u32 s31, s31, s27
    s_xor_b32 s36, s30, 1
    v_mfma_f32_16x16x32_bf16 v[56:59], v[136:139], v[108:111], v[56:59]
    s_xor_b32 s37, s31, 1
    s_lshl_b32 s38, s20, 13
    s_lshl_b32 s39, s30, 15
    s_add_u32 s39, s39, s38
    v_mfma_f32_16x16x32_bf16 v[20:23], v[128:131], v[112:115], v[20:23]
    s_add_u32 s39, s39, 0x480000
    v_add_u32 v3, s39, v1
    s_lshl_b32 s39, s36, 15
    v_mfma_f32_16x16x32_bf16 v[40:43], v[132:135], v[112:115], v[40:43]
    s_add_u32 s39, s39, s38
    s_add_u32 s39, s39, 0x480000
    v_add_u32 v4, s39, v1
    s_lshl_b32 s39, s31, 15
    v_mfma_f32_16x16x32_bf16 v[60:63], v[136:139], v[112:115], v[60:63]
    s_add_u32 s39, s39, s38
    s_add_u32 s39, s39, 0x0
    v_add_u32 v5, s39, v1
    v_mfma_f32_16x16x32_bf16 v[24:27], v[128:131], v[116:119], v[24:27]
    s_lshl_b32 s39, s37, 15
    s_add_u32 s39, s39, s38
    s_add_u32 s39, s39, 0x0
    v_add_u32 v6, s39, v1
    v_mfma_f32_16x16x32_bf16 v[44:47], v[132:135], v[116:119], v[44:47]
    s_mul_i32 s38, s20, 28672
    s_mul_i32 s39, s30, 114688
    s_add_u32 s39, s39, s38
    v_mfma_f32_16x16x32_bf16 v[64:67], v[136:139], v[116:119], v[64:67]
    s_add_u32 s39, s39, 0x880000
    v_add_u32 v7, s39, v1
    s_mul_i32 s39, s36, 114688
    s_add_u32 s39, s39, s38
    v_mfma_f32_16x16x32_bf16 v[28:31], v[128:131], v[120:123], v[28:31]
    s_add_u32 s39, s39, 0x880000
    v_add_u32 v8, s39, v1
    s_movk_i32 s52, 0x0
    v_mfma_f32_16x16x32_bf16 v[48:51], v[132:135], v[120:123], v[48:51]
    s_movk_i32 s53, 0x1000
    s_movk_i32 s54, 0x2000
    s_movk_i32 s55, 0x3000
    s_movk_i32 s56, 0x4000
    v_mfma_f32_16x16x32_bf16 v[68:71], v[136:139], v[120:123], v[68:71]
    s_movk_i32 s57, 0x5000
    s_movk_i32 s58, 0x6000
    s_mul_i32 s39, s22, 896
    v_mfma_f32_16x16x32_bf16 v[32:35], v[128:131], v[124:127], v[32:35]
    s_add_u32 s39, s39, 0x440000
    v_lshlrev_b32 v9, 2, v0
    v_add_u32 v9, s39, v9
    v_and_b32 v11, 31, v0
    v_mfma_f32_16x16x32_bf16 v[52:55], v[132:135], v[124:127], v[52:55]
    v_lshlrev_b32 v11, 10, v11
    v_bfe_u32 v10, v0, 5, 1
    v_lshl_add_u32 v11, v10, 4, v11
    v_mfma_f32_16x16x32_bf16 v[72:75], v[136:139], v[124:127], v[72:75]
    s_lshl_b32 s38, s31, 15
    s_lshl_b32 s39, s30, 6
    s_add_u32 s38, s38, s39
    s_mov_b32 s29, 0
L_gr_23:
    v_xor_b32 v188, s23, v201
    v_xor_b32 v189, s23, v203
    v_or_b32 v188, v188, v189
    v_xor_b32 v189, s23, v205
    v_or_b32 v188, v188, v189
    v_xor_b32 v189, s23, v207
    v_or_b32 v188, v188, v189
    v_xor_b32 v189, s23, v209
    v_or_b32 v188, v188, v189
    v_xor_b32 v189, s23, v211
    v_or_b32 v188, v188, v189
    v_xor_b32 v189, s23, v213
    v_or_b32 v188, v188, v189
    v_xor_b32 v189, s23, v215
    v_or_b32 v188, v188, v189
    v_xor_b32 v189, s23, v217
    v_or_b32 v188, v188, v189
    v_xor_b32 v189, s23, v219
    v_or_b32 v188, v188, v189
    v_cmp_ne_u32 vcc, 0, v188
    s_cbranch_vccz L_gd_24
    s_add_u32 s29, s29, 1
    s_cmp_ge_u32 s29, 32768
    s_cbranch_scc1 L_gd_24
    v_and_b32 v12, 15, v2
    v_lshlrev_b32 v12, 4, v12
    buffer_load_dwordx4 v[200:203], v12, s[8:11], s84 offen sc1
    buffer_load_dwordx4 v[204:207], v12, s[8:11], s85 offen offset:0 sc1
    buffer_load_dwordx4 v[208:211], v12, s[8:11], s85 offen offset:256 sc1
    buffer_load_dwordx4 v[212:215], v12, s[8:11], s85 offen offset:512 sc1
    buffer_load_dwordx4 v[216:219], v12, s[8:11], s85 offen offset:768 sc1
    s_waitcnt vmcnt(0)
    s_branch L_gr_23
L_gd_24:
    v_mov_b32_dpp v76, v16 row_newbcast:0 row_mask:0xf bank_mask:0xf
    v_mov_b32_dpp v80, v36 row_newbcast:0 row_mask:0xf bank_mask:0xf
    buffer_load_dwordx4 a[192:195], v3, s[8:11], s52 offen offset:0 sc1
    v_mov_b32_dpp v84, v56 row_newbcast:0 row_mask:0xf bank_mask:0xf
    v_mov_b32_dpp v77, v17 row_newbcast:0 row_mask:0xf bank_mask:0xf
    v_mov_b32_dpp v81, v37 row_newbcast:0 row_mask:0xf bank_mask:0xf
    v_mov_b32_dpp v85, v57 row_newbcast:0 row_mask:0xf bank_mask:0xf
    buffer_load_dwordx4 a[196:199], v3, s[8:11], s52 offen offset:1024 sc1
    v_mov_b32_dpp v78, v18 row_newbcast:0 row_mask:0xf bank_mask:0xf
    v_mov_b32_dpp v82, v38 row_newbcast:0 row_mask:0xf bank_mask:0xf
    v_mov_b32_dpp v86, v58 row_newbcast:0 row_mask:0xf bank_mask:0xf
    v_mov_b32_dpp v79, v19 row_newbcast:0 row_mask:0xf bank_mask:0xf
    buffer_load_dwordx4 a[200:203], v3, s[8:11], s52 offen offset:2048 sc1
    v_mov_b32_dpp v83, v39 row_newbcast:0 row_mask:0xf bank_mask:0xf
    v_mov_b32_dpp v87, v59 row_newbcast:0 row_mask:0xf bank_mask:0xf
    v_pk_mul_f32 v[126:127], v[84:85], v[202:203] op_sel_hi:[1,0]
    v_pk_mul_f32 v[128:129], v[86:87], v[202:203] op_sel_hi:[1,0]
    v_pk_fma_f32 v[126:127], v[56:57], v[200:201], v[126:127] op_sel_hi:[1,0,1] neg_lo:[0,0,1] neg_hi:[0,0,1]
    v_pk_fma_f32 v[128:129], v[58:59], v[200:201], v[128:129] op_sel_hi:[1,0,1] neg_lo:[0,0,1] neg_hi:[0,0,1]
    buffer_load_dwordx4 a[204:207], v3, s[8:11], s52 offen offset:3072 sc1
    v_cvt_pk_bf16_f32 v106, v126, v127
    v_cvt_pk_bf16_f32 v107, v128, v129
    v_pk_mul_f32 v[130:131], v[84:85], v[206:207] op_sel_hi:[1,0]
    v_pk_mul_f32 v[132:133], v[86:87], v[206:207] op_sel_hi:[1,0]
    v_pk_fma_f32 v[130:131], v[60:61], v[204:205], v[130:131] op_sel_hi:[1,0,1] neg_lo:[0,0,1] neg_hi:[0,0,1]
    v_pk_fma_f32 v[132:133], v[62:63], v[204:205], v[132:133] op_sel_hi:[1,0,1] neg_lo:[0,0,1] neg_hi:[0,0,1]
    v_cvt_pk_bf16_f32 v108, v130, v131
    v_cvt_pk_bf16_f32 v109, v132, v133
    buffer_load_dwordx4 a[208:211], v3, s[8:11], s53 offen offset:0 sc1
    v_pk_mul_f32 v[126:127], v[84:85], v[210:211] op_sel_hi:[1,0]
    v_pk_mul_f32 v[128:129], v[86:87], v[210:211] op_sel_hi:[1,0]
    v_pk_fma_f32 v[126:127], v[64:65], v[208:209], v[126:127] op_sel_hi:[1,0,1] neg_lo:[0,0,1] neg_hi:[0,0,1]
    v_pk_fma_f32 v[128:129], v[66:67], v[208:209], v[128:129] op_sel_hi:[1,0,1] neg_lo:[0,0,1] neg_hi:[0,0,1]
    v_cvt_pk_bf16_f32 v110, v126, v127
    v_cvt_pk_bf16_f32 v111, v128, v129
    v_pk_mul_f32 v[130:131], v[84:85], v[214:215] op_sel_hi:[1,0]
    v_pk_mul_f32 v[132:133], v[86:87], v[214:215] op_sel_hi:[1,0]
    buffer_load_dwordx4 a[212:215], v3, s[8:11], s53 offen offset:1024 sc1
    v_pk_fma_f32 v[130:131], v[68:69], v[212:213], v[130:131] op_sel_hi:[1,0,1] neg_lo:[0,0,1] neg_hi:[0,0,1]
    v_pk_fma_f32 v[132:133], v[70:71], v[212:213], v[132:133] op_sel_hi:[1,0,1] neg_lo:[0,0,1] neg_hi:[0,0,1]
    v_cvt_pk_bf16_f32 v112, v130, v131
    v_cvt_pk_bf16_f32 v113, v132, v133
    v_pk_mul_f32 v[126:127], v[84:85], v[218:219] op_sel_hi:[1,0]
    v_pk_mul_f32 v[128:129], v[86:87], v[218:219] op_sel_hi:[1,0]
    v_pk_fma_f32 v[126:127], v[72:73], v[216:217], v[126:127] op_sel_hi:[1,0,1] neg_lo:[0,0,1] neg_hi:[0,0,1]
    v_pk_fma_f32 v[128:129], v[74:75], v[216:217], v[128:129] op_sel_hi:[1,0,1] neg_lo:[0,0,1] neg_hi:[0,0,1]
    buffer_load_dwordx4 a[216:219], v3, s[8:11], s53 offen offset:2048 sc1
    v_cvt_pk_bf16_f32 v114, v126, v127
    v_cvt_pk_bf16_f32 v115, v128, v129
    v_pk_mul_f32 v[130:131], v[80:81], v[202:203] op_sel_hi:[1,0]
    v_pk_mul_f32 v[132:133], v[82:83], v[202:203] op_sel_hi:[1,0]
    v_pk_fma_f32 v[130:131], v[36:37], v[200:201], v[130:131] op_sel_hi:[1,0,1] neg_lo:[0,0,1] neg_hi:[0,0,1]
    v_pk_fma_f32 v[132:133], v[38:39], v[200:201], v[132:133] op_sel_hi:[1,0,1] neg_lo:[0,0,1] neg_hi:[0,0,1]
    v_cvt_pk_bf16_f32 v96, v130, v131
    v_cvt_pk_bf16_f32 v97, v132, v133
    buffer_load_dwordx4 a[220:223], v3, s[8:11], s53 offen offset:3072 sc1
    v_pk_mul_f32 v[126:127], v[80:81], v[206:207] op_sel_hi:[1,0]
    v_pk_mul_f32 v[128:129], v[82:83], v[206:207] op_sel_hi:[1,0]
    v_pk_fma_f32 v[126:127], v[40:41], v[204:205], v[126:127] op_sel_hi:[1,0,1] neg_lo:[0,0,1] neg_hi:[0,0,1]
    v_pk_fma_f32 v[128:129], v[42:43], v[204:205], v[128:129] op_sel_hi:[1,0,1] neg_lo:[0,0,1] neg_hi:[0,0,1]
    v_cvt_pk_bf16_f32 v98, v126, v127
    v_cvt_pk_bf16_f32 v99, v128, v129
    v_pk_mul_f32 v[130:131], v[80:81], v[210:211] op_sel_hi:[1,0]
    v_pk_mul_f32 v[132:133], v[82:83], v[210:211] op_sel_hi:[1,0]
    buffer_load_dwordx4 a[224:227], v4, s[8:11], s52 offen offset:0 sc1
    v_pk_fma_f32 v[130:131], v[44:45], v[208:209], v[130:131] op_sel_hi:[1,0,1] neg_lo:[0,0,1] neg_hi:[0,0,1]
    v_pk_fma_f32 v[132:133], v[46:47], v[208:209], v[132:133] op_sel_hi:[1,0,1] neg_lo:[0,0,1] neg_hi:[0,0,1]
    v_cvt_pk_bf16_f32 v100, v130, v131
    v_cvt_pk_bf16_f32 v101, v132, v133
    v_pk_mul_f32 v[126:127], v[80:81], v[214:215] op_sel_hi:[1,0]
    v_pk_mul_f32 v[128:129], v[82:83], v[214:215] op_sel_hi:[1,0]
    v_pk_fma_f32 v[126:127], v[48:49], v[212:213], v[126:127] op_sel_hi:[1,0,1] neg_lo:[0,0,1] neg_hi:[0,0,1]
    v_pk_fma_f32 v[128:129], v[50:51], v[212:213], v[128:129] op_sel_hi:[1,0,1] neg_lo:[0,0,1] neg_hi:[0,0,1]
    buffer_load_dwordx4 a[228:231], v4, s[8:11], s52 offen offset:1024 sc1
    v_cvt_pk_bf16_f32 v102, v126, v127
    v_cvt_pk_bf16_f32 v103, v128, v129
    v_pk_mul_f32 v[130:131], v[80:81], v[218:219] op_sel_hi:[1,0]
    v_pk_mul_f32 v[132:133], v[82:83], v[218:219] op_sel_hi:[1,0]
    v_pk_fma_f32 v[130:131], v[52:53], v[216:217], v[130:131] op_sel_hi:[1,0,1] neg_lo:[0,0,1] neg_hi:[0,0,1]
    v_pk_fma_f32 v[132:133], v[54:55], v[216:217], v[132:133] op_sel_hi:[1,0,1] neg_lo:[0,0,1] neg_hi:[0,0,1]
    v_cvt_pk_bf16_f32 v104, v130, v131
    v_cvt_pk_bf16_f32 v105, v132, v133
    buffer_load_dwordx4 a[232:235], v4, s[8:11], s52 offen offset:2048 sc1
    v_mfma_f32_16x16x16_bf16 v[140:143], v[106:107], v[198:199], 0
    v_mfma_f32_16x16x16_bf16 v[144:147], v[108:109], v[198:199], 0
    v_mfma_f32_16x16x16_bf16 v[148:151], v[110:111], v[198:199], 0
    v_mfma_f32_16x16x16_bf16 v[152:155], v[112:113], v[198:199], 0
    buffer_load_dwordx4 a[236:239], v4, s[8:11], s52 offen offset:3072 sc1
    v_mfma_f32_16x16x16_bf16 v[156:159], v[114:115], v[198:199], 0
    v_pk_mul_f32 v[126:127], v[76:77], v[206:207] op_sel_hi:[1,0]
    v_pk_mul_f32 v[128:129], v[78:79], v[206:207] op_sel_hi:[1,0]
    v_pk_fma_f32 v[126:127], v[20:21], v[204:205], v[126:127] op_sel_hi:[1,0,1] neg_lo:[0,0,1] neg_hi:[0,0,1]
    v_pk_fma_f32 v[128:129], v[22:23], v[204:205], v[128:129] op_sel_hi:[1,0,1] neg_lo:[0,0,1] neg_hi:[0,0,1]
    v_cvt_pk_bf16_f32 v88, v126, v127
    v_cvt_pk_bf16_f32 v89, v128, v129
    buffer_load_dwordx4 a[240:243], v4, s[8:11], s53 offen offset:0 sc1
    v_pk_mul_f32 v[130:131], v[76:77], v[210:211] op_sel_hi:[1,0]
    v_pk_mul_f32 v[132:133], v[78:79], v[210:211] op_sel_hi:[1,0]
    v_pk_fma_f32 v[130:131], v[24:25], v[208:209], v[130:131] op_sel_hi:[1,0,1] neg_lo:[0,0,1] neg_hi:[0,0,1]
    v_pk_fma_f32 v[132:133], v[26:27], v[208:209], v[132:133] op_sel_hi:[1,0,1] neg_lo:[0,0,1] neg_hi:[0,0,1]
    v_cvt_pk_bf16_f32 v90, v130, v131
    v_cvt_pk_bf16_f32 v91, v132, v133
    v_pk_mul_f32 v[126:127], v[76:77], v[214:215] op_sel_hi:[1,0]
    v_pk_mul_f32 v[128:129], v[78:79], v[214:215] op_sel_hi:[1,0]
    buffer_load_dwordx4 a[244:247], v4, s[8:11], s53 offen offset:1024 sc1
    v_pk_fma_f32 v[126:127], v[28:29], v[212:213], v[126:127] op_sel_hi:[1,0,1] neg_lo:[0,0,1] neg_hi:[0,0,1]
    v_pk_fma_f32 v[128:129], v[30:31], v[212:213], v[128:129] op_sel_hi:[1,0,1] neg_lo:[0,0,1] neg_hi:[0,0,1]
    v_cvt_pk_bf16_f32 v92, v126, v127
    v_cvt_pk_bf16_f32 v93, v128, v129
    v_pk_mul_f32 v[130:131], v[76:77], v[218:219] op_sel_hi:[1,0]
    v_pk_mul_f32 v[132:133], v[78:79], v[218:219] op_sel_hi:[1,0]
    v_pk_fma_f32 v[130:131], v[32:33], v[216:217], v[130:131] op_sel_hi:[1,0,1] neg_lo:[0,0,1] neg_hi:[0,0,1]
    v_pk_fma_f32 v[132:133], v[34:35], v[216:217], v[132:133] op_sel_hi:[1,0,1] neg_lo:[0,0,1] neg_hi:[0,0,1]
    buffer_load_dwordx4 a[248:251], v4, s[8:11], s53 offen offset:2048 sc1
    v_cvt_pk_bf16_f32 v94, v130, v131
    v_cvt_pk_bf16_f32 v95, v132, v133
    v_cvt_pk_bf16_f32 v116, v140, v141
    v_cvt_pk_bf16_f32 v117, v142, v143
    v_cvt_pk_bf16_f32 v118, v144, v145
    v_cvt_pk_bf16_f32 v119, v146, v147
    v_cvt_pk_bf16_f32 v120, v148, v149
    v_cvt_pk_bf16_f32 v121, v150, v151
    buffer_load_dwordx4 a[252:255], v4, s[8:11], s53 offen offset:3072 sc1
    v_cvt_pk_bf16_f32 v122, v152, v153
    v_cvt_pk_bf16_f32 v123, v154, v155
    v_cvt_pk_bf16_f32 v124, v156, v157
    v_cvt_pk_bf16_f32 v125, v158, v159
    s_cmp_eq_u32 s26, 0
    s_cselect_b32 s92, -1, 0
    s_mov_b32 s93, s92
    s_mov_b32 s94, 0x3eb8aa3b
    s_lshl_b32 s95, s26, 16
    s_lshl_b32 s27, s25, 12
    s_add_u32 s95, s95, s27
    s_lshl_b32 s27, s20, 10
    s_add_u32 s95, s95, s27
    s_add_u32 s95, s95, 0x0
    buffer_load_dwordx4 v[172:175], v11, s[4:7], s38 offen
    v_mfma_f32_16x16x16_bf16 v[16:19], v[98:99], v[88:89], 0
    v_mfma_f32_16x16x16_bf16 v[36:39], v[96:97], v[88:89], 0
    v_mfma_f32_16x16x16_bf16 v[20:23], v[100:101], v[90:91], 0
    v_mfma_f32_16x16x16_bf16 v[40:43], v[98:99], v[90:91], 0
    v_mfma_f32_16x16x16_bf16 v[24:27], v[102:103], v[92:93], 0
    v_mfma_f32_16x16x16_bf16 v[44:47], v[100:101], v[92:93], 0
    v_mfma_f32_16x16x16_bf16 v[28:31], v[104:105], v[94:95], 0
    v_mfma_f32_16x16x16_bf16 v[48:51], v[102:103], v[94:95], 0
    buffer_load_dwordx4 v[176:179], v11, s[4:7], s38 offen offset:32
    s_nop 4
    v_cndmask_b32 v16, v16, v17, s[88:89]
    v_cndmask_b32 v18, v18, v19, s[88:89]
    v_cndmask_b32 v36, v36, v37, s[88:89]
    v_cndmask_b32 v38, v38, v39, s[88:89]
    v_cndmask_b32 v36, v36, v14, s[92:93]
    v_cndmask_b32 v38, v38, v14, s[92:93]
    v_cndmask_b32 v180, v36, v16, s[82:83]
    v_cndmask_b32 v181, v38, v18, s[90:91]
    v_max_f32 v182, v180, v181
    v_mov_b32 v183, v182
    v_cndmask_b32 v20, v20, v21, s[88:89]
    v_cndmask_b32 v22, v22, v23, s[88:89]
    v_cndmask_b32 v40, v40, v41, s[88:89]
    v_cndmask_b32 v42, v42, v43, s[88:89]
    v_cndmask_b32 v184, v40, v20, s[82:83]
    v_cndmask_b32 v185, v42, v22, s[90:91]
    v_max_f32 v186, v184, v185
    v_mov_b32 v187, v186
    v_cndmask_b32 v24, v24, v25, s[88:89]
    v_cndmask_b32 v26, v26, v27, s[88:89]
    v_cndmask_b32 v44, v44, v45, s[88:89]
    v_cndmask_b32 v46, v46, v47, s[88:89]
    v_cndmask_b32 v188, v44, v24, s[82:83]
    v_cndmask_b32 v189, v46, v26, s[90:91]
    v_max_f32 v190, v188, v189
    v_mov_b32 v191, v190
    s_mov_b32 s39, 0
    buffer_load_dword v164, v9, s[8:11], s39 offen sc1
    v_cndmask_b32 v28, v28, v29, s[88:89]
    v_cndmask_b32 v30, v30, v31, s[88:89]
    v_cndmask_b32 v48, v48, v49, s[88:89]
    v_cndmask_b32 v50, v50, v51, s[88:89]
    v_cndmask_b32 v192, v48, v28, s[82:83]
    v_cndmask_b32 v193, v50, v30, s[90:91]
    v_max_f32 v194, v192, v193
    v_mov_b32 v195, v194
    s_nop 0
    v_permlane16_swap_b32 v182, v183
    v_permlane16_swap_b32 v186, v187
    v_permlane16_swap_b32 v190, v191
    v_permlane16_swap_b32 v194, v195
    s_nop 0
    v_max_f32 v182, v182, v183
    v_max_f32 v186, v186, v187
    v_max_f32 v190, v190, v191
    v_max_f32 v194, v194, v195
    v_mov_b32 v183, v182
    v_mov_b32 v187, v186
    v_mov_b32 v191, v190
    v_mov_b32 v195, v194
    s_nop 0
    v_permlane32_swap_b32 v182, v183
    v_permlane32_swap_b32 v186, v187
    v_permlane32_swap_b32 v190, v191
    v_permlane32_swap_b32 v194, v195
    s_nop 0
    s_mov_b32 s39, 14336
    buffer_load_dword v165, v9, s[8:11], s39 offen sc1
    v_max_f32 v182, v182, v183
    v_max_f32 v186, v186, v187
    v_max_f32 v190, v190, v191
    v_max_f32 v194, v194, v195
    v_mul_f32 v182, s94, v182
    v_mul_f32 v186, s94, v186
    v_mul_f32 v190, s94, v190
    v_mul_f32 v194, s94, v194
    v_fma_f32 v180, v180, s94, -v182
    v_fma_f32 v181, v181, s94, -v182
    v_fma_f32 v184, v184, s94, -v186
    v_fma_f32 v185, v185, s94, -v186
    s_mov_b32 s39, 28672
    buffer_load_dword v166, v9, s[8:11], s39 offen sc1
    v_fma_f32 v188, v188, s94, -v190
    v_fma_f32 v189, v189, s94, -v190
    v_fma_f32 v192, v192, s94, -v194
    v_fma_f32 v193, v193, s94, -v194
    v_exp_f32 v180, v180
    v_exp_f32 v181, v181
    v_exp_f32 v184, v184
    v_exp_f32 v185, v185
    s_mov_b32 s39, 43008
    buffer_load_dword v167, v9, s[8:11], s39 offen sc1
    v_exp_f32 v188, v188
    v_exp_f32 v189, v189
    v_exp_f32 v192, v192
    v_exp_f32 v193, v193
    v_cvt_pk_bf16_f32 v180, v180, 0
    v_cvt_pk_bf16_f32 v181, v181, 0
    v_cvt_pk_bf16_f32 v184, v184, 0
    v_cvt_pk_bf16_f32 v185, v185, 0
    s_mov_b32 s39, 57344
    buffer_load_dword v168, v9, s[8:11], s39 offen sc1
    v_cvt_pk_bf16_f32 v188, v188, 0
    v_cvt_pk_bf16_f32 v189, v189, 0
    v_cvt_pk_bf16_f32 v192, v192, 0
    v_cvt_pk_bf16_f32 v193, v193, 0
    v_lshlrev_b32 v180, v15, v180
    v_lshlrev_b32 v181, v15, v181
    v_lshlrev_b32 v184, v15, v184
    v_lshlrev_b32 v185, v15, v185
    s_mov_b32 s39, 71680
    buffer_load_dword v169, v9, s[8:11], s39 offen sc1
    v_lshlrev_b32 v188, v15, v188
    v_lshlrev_b32 v189, v15, v189
    v_lshlrev_b32 v192, v15, v192
    v_lshlrev_b32 v193, v15, v193
    v_cndmask_b32 v196, v180, 0, s[82:83]
    v_cndmask_b32 v197, v181, 0, s[90:91]
    v_cndmask_b32 v198, 0, v180, s[82:83]
    v_cndmask_b32 v199, 0, v181, s[90:91]
    v_cndmask_b32 v200, v184, 0, s[82:83]
    v_cndmask_b32 v201, v185, 0, s[90:91]
    v_cndmask_b32 v202, 0, v184, s[82:83]
    v_cndmask_b32 v203, 0, v185, s[90:91]
    s_mov_b32 s39, 86016
    buffer_load_dword v170, v9, s[8:11], s39 offen sc1
    v_cndmask_b32 v204, v188, 0, s[82:83]
    v_cndmask_b32 v205, v189, 0, s[90:91]
    v_cndmask_b32 v206, 0, v188, s[82:83]
    v_cndmask_b32 v207, 0, v189, s[90:91]
    v_cndmask_b32 v208, v192, 0, s[82:83]
    v_cndmask_b32 v209, v193, 0, s[90:91]
    v_cndmask_b32 v210, 0, v192, s[82:83]
    v_cndmask_b32 v211, 0, v193, s[90:91]
    s_nop 0
    v_mfma_f32_16x16x32_bf16 v[16:19], v[116:119], v[196:199], 0
    v_mfma_f32_16x16x32_bf16 v[36:39], v[220:223], v[196:199], 0
    s_mov_b32 s39, 100352
    buffer_load_dword v171, v9, s[8:11], s39 offen sc1
    v_mfma_f32_16x16x32_bf16 v[20:23], v[118:121], v[200:203], 0
    v_mfma_f32_16x16x32_bf16 v[40:43], v[220:223], v[200:203], 0
    v_mfma_f32_16x16x32_bf16 v[24:27], v[120:123], v[204:207], 0
    v_mfma_f32_16x16x32_bf16 v[44:47], v[220:223], v[204:207], 0
    v_mfma_f32_16x16x32_bf16 v[28:31], v[122:125], v[208:211], 0
    v_mfma_f32_16x16x32_bf16 v[48:51], v[220:223], v[208:211], 0
    s_nop 4
    v_rcp_f32 v180, v36
    v_rcp_f32 v184, v40
    v_rcp_f32 v188, v44
    v_rcp_f32 v192, v48
    s_nop 0
    v_pk_mul_f32 v[16:17], v[16:17], v[180:181] op_sel_hi:[1,0]
    v_pk_mul_f32 v[18:19], v[18:19], v[180:181] op_sel_hi:[1,0]
    v_pk_mul_f32 v[20:21], v[20:21], v[184:185] op_sel_hi:[1,0]
    v_pk_mul_f32 v[22:23], v[22:23], v[184:185] op_sel_hi:[1,0]
    v_pk_mul_f32 v[24:25], v[24:25], v[188:189] op_sel_hi:[1,0]
    v_pk_mul_f32 v[26:27], v[26:27], v[188:189] op_sel_hi:[1,0]
    v_pk_mul_f32 v[28:29], v[28:29], v[192:193] op_sel_hi:[1,0]
    v_pk_mul_f32 v[30:31], v[30:31], v[192:193] op_sel_hi:[1,0]
    v_cvt_pk_bf16_f32 v16, v16, v17
    v_cvt_pk_bf16_f32 v17, v18, v19
    buffer_store_dwordx2 v[16:17], v224, s[72:75], s95 offen sc1
    buffer_store_dwordx2 v[16:17], v224, s[76:79], s95 offen
    v_cvt_pk_bf16_f32 v20, v20, v21
    v_cvt_pk_bf16_f32 v21, v22, v23
    buffer_store_dwordx2 v[20:21], v224, s[72:75], s95 offen offset:256 sc1
    buffer_store_dwordx2 v[20:21], v224, s[76:79], s95 offen offset:256
    v_cvt_pk_bf16_f32 v24, v24, v25
    v_cvt_pk_bf16_f32 v25, v26, v27
    s_add_u32 s95, s95, 32768
    buffer_store_dwordx2 v[24:25], v224, s[72:75], s95 offen sc1
    buffer_store_dwordx2 v[24:25], v224, s[76:79], s95 offen
    v_cvt_pk_bf16_f32 v28, v28, v29
    v_cvt_pk_bf16_f32 v29, v30, v31
    buffer_store_dwordx2 v[28:29], v224, s[72:75], s95 offen offset:256 sc1
    buffer_store_dwordx2 v[28:29], v224, s[76:79], s95 offen offset:256
    s_mul_i32 s36, s22, 229376
    s_lshl_b32 s37, s20, 13
    s_add_u32 s36, s36, s37
    s_add_u32 s36, s36, 0x500000
    s_mov_b32 s40, s8
    s_mov_b32 s41, s9
    s_mov_b32 s42, s10
    s_mov_b32 s43, 0x20000
    s_waitcnt vmcnt(8)
    v_add_f32 v164, v164, v165
    v_add_f32 v164, v164, v166
    v_add_f32 v164, v164, v167
    v_add_f32 v164, v164, v168
    v_add_f32 v164, v164, v169
    v_add_f32 v164, v164, v170
    v_add_f32 v164, v164, v171
    v_lshlrev_b32 v165, 2, v0
    v_add_u32 v165, 147456, v165
    ds_write_b32 v165, v164
    s_waitcnt vmcnt(0)
    s_barrier
    s_lshl_b32 s27, s21, 7
    s_lshl_b32 s28, s22, 2
    s_add_u32 s27, s27, s28
    s_add_u32 s27, s27, 0x1300400
    s_cmp_lg_u32 s20, 0
    s_cbranch_scc1 L_fs_25
    v_mov_b32 v12, s23
    v_mov_b32 v13, 0
    s_mov_b64 exec, 1
    buffer_store_dword v12, v13, s[72:75], s27 offen sc1
    buffer_store_dword v12, v13, s[76:79], s27 offen
    s_mov_b64 exec, -1
L_fs_25:
    s_cmp_lg_u32 s20, 0
    s_cbranch_scc1 L_pd_26
    s_cmp_ge_u32 s3, 224
    s_cbranch_scc1 L_pd_26
    s_lshl_b32 s80, s62, 7
    s_lshl_b32 s81, s63, 2
    s_add_u32 s80, s80, s81
    s_add_u32 s80, s80, 0x1303000
    v_mov_b32 v184, s23
    v_mov_b32 v185, 0
    s_mov_b64 exec, 1
    buffer_store_dword v184, v185, s[8:11], s80 offen sc1
    s_mov_b64 exec, -1
L_pd_26:
    s_mov_b32 m0, s37
    s_nop 0
    buffer_load_dwordx4 v1, s[40:43], s36 offen offset:0 sc1 lds
    buffer_load_dwordx4 v1, s[40:43], s36 offen offset:1024 sc1 lds
    buffer_load_dwordx4 v1, s[40:43], s36 offen offset:2048 sc1 lds
    buffer_load_dwordx4 v1, s[40:43], s36 offen offset:3072 sc1 lds
    s_add_u32 s36, s36, 4096
    s_add_u32 s37, s37, 4096
    s_mov_b32 m0, s37
    s_nop 0
    buffer_load_dwordx4 v1, s[40:43], s36 offen offset:0 sc1 lds
    buffer_load_dwordx4 v1, s[40:43], s36 offen offset:1024 sc1 lds
    buffer_load_dwordx4 v1, s[40:43], s36 offen offset:2048 sc1 lds
    buffer_load_dwordx4 v1, s[40:43], s36 offen offset:3072 sc1 lds
    s_add_u32 s36, s36, 28672
    s_add_u32 s37, s37, 28672
    s_and_b32 s37, s37, 0x1ffff
    s_mov_b32 m0, s37
    s_nop 0
    buffer_load_dwordx4 v1, s[40:43], s36 offen offset:0 sc1 lds
    buffer_load_dwordx4 v1, s[40:43], s36 offen offset:1024 sc1 lds
    buffer_load_dwordx4 v1, s[40:43], s36 offen offset:2048 sc1 lds
    buffer_load_dwordx4 v1, s[40:43], s36 offen offset:3072 sc1 lds
    s_add_u32 s36, s36, 4096
    s_add_u32 s37, s37, 4096
    s_mov_b32 m0, s37
    s_nop 0
    buffer_load_dwordx4 v1, s[40:43], s36 offen offset:0 sc1 lds
    buffer_load_dwordx4 v1, s[40:43], s36 offen offset:1024 sc1 lds
    buffer_load_dwordx4 v1, s[40:43], s36 offen offset:2048 sc1 lds
    buffer_load_dwordx4 v1, s[40:43], s36 offen offset:3072 sc1 lds
    s_add_u32 s36, s36, 28672
    s_add_u32 s37, s37, 28672
    s_and_b32 s37, s37, 0x1ffff
    v_and_b32 v12, 7, v2
    v_lshlrev_b32 v12, 3, v12
    s_lshl_b32 s27, s21, 7
    s_lshl_b32 s28, s24, 2
    s_add_u32 s27, s27, s28
    s_add_u32 s27, s27, 0x1300400
    s_cmp_lg_u32 s20, 0
    s_cbranch_scc1 L_wp_27
    s_mov_b32 s29, 0
L_poll_28:
    buffer_load_dword v13, v12, s[8:11], s27 offen sc1
    s_add_u32 s29, s29, 1
    s_cmp_ge_u32 s29, 32768
    s_waitcnt vmcnt(0)
    s_cbranch_scc1 L_pd_29
    v_cmp_ne_u32 vcc, s23, v13
    s_cbranch_vccnz L_poll_28
L_pd_29:
L_wp_27:
    s_waitcnt vmcnt(0)
    s_barrier
    buffer_load_dwordx4 v[80:83], v5, s[8:11], s52 offen offset:0 sc1
    buffer_load_dwordx4 v[84:87], v6, s[8:11], s52 offen offset:0 sc1
    buffer_load_dwordx4 v[88:91], v5, s[8:11], s52 offen offset:1024 sc1
    buffer_load_dwordx4 v[92:95], v6, s[8:11], s52 offen offset:1024 sc1
    buffer_load_dwordx4 v[96:99], v5, s[8:11], s52 offen offset:2048 sc1
    buffer_load_dwordx4 v[100:103], v6, s[8:11], s52 offen offset:2048 sc1
    buffer_load_dwordx4 v[104:107], v5, s[8:11], s52 offen offset:3072 sc1
    buffer_load_dwordx4 v[108:111], v6, s[8:11], s52 offen offset:3072 sc1
    buffer_load_dwordx4 v[112:115], v5, s[8:11], s53 offen offset:0 sc1
    buffer_load_dwordx4 v[116:119], v6, s[8:11], s53 offen offset:0 sc1
    buffer_load_dwordx4 v[120:123], v5, s[8:11], s53 offen offset:1024 sc1
    buffer_load_dwordx4 v[124:127], v6, s[8:11], s53 offen offset:1024 sc1
    buffer_load_dwordx4 v[128:131], v5, s[8:11], s53 offen offset:2048 sc1
    buffer_load_dwordx4 v[132:135], v6, s[8:11], s53 offen offset:2048 sc1
    buffer_load_dwordx4 v[136:139], v5, s[8:11], s53 offen offset:3072 sc1
    buffer_load_dwordx4 v[140:143], v6, s[8:11], s53 offen offset:3072 sc1
    s_cmp_lg_u32 s20, 0
    s_cbranch_scc1 L_fd_30
    v_min_u32 v151, 27, v2
    s_lshl_b32 s80, s25, 7
    s_add_u32 s80, s80, 0x1303000
    v_lshl_add_u32 v151, v151, 2, s80
    buffer_load_dword v150, v151, s[8:11], 0 offen sc1
L_fd_30:
    s_waitcnt vmcnt(14)
    v_mfma_f32_32x32x16_bf16 v[16:31], a[192:195], v[80:83], 0
    v_mfma_f32_32x32x16_bf16 v[32:47], a[224:227], v[80:83], 0
    v_mfma_f32_32x32x16_bf16 v[48:63], a[192:195], v[84:87], 0
    v_mfma_f32_32x32x16_bf16 v[64:79], a[224:227], v[84:87], 0
    s_mov_b32 m0, s37
    s_nop 0
    buffer_load_dwordx4 v1, s[40:43], s36 offen offset:0 sc1 lds
    s_xor_b32 s82, s20, 1
    s_mul_i32 s82, s82, 12288
    s_add_u32 s82, s82, 98304
    v_add_u32 v12, s82, v1
    s_xor_b32 s82, s20, 2
    s_waitcnt vmcnt(13)
    v_mfma_f32_32x32x16_bf16 v[16:31], a[196:199], v[88:91], v[16:31]
    v_mfma_f32_32x32x16_bf16 v[32:47], a[228:231], v[88:91], v[32:47]
    v_mfma_f32_32x32x16_bf16 v[48:63], a[196:199], v[92:95], v[48:63]
    v_mfma_f32_32x32x16_bf16 v[64:79], a[228:231], v[92:95], v[64:79]
    buffer_load_dwordx4 v1, s[40:43], s36 offen offset:1024 sc1 lds
    s_mul_i32 s82, s82, 12288
    s_add_u32 s82, s82, 102400
    v_add_u32 v13, s82, v1
    s_xor_b32 s82, s20, 3
    s_waitcnt vmcnt(12)
    v_mfma_f32_32x32x16_bf16 v[16:31], a[200:203], v[96:99], v[16:31]
    v_mfma_f32_32x32x16_bf16 v[32:47], a[232:235], v[96:99], v[32:47]
    v_mfma_f32_32x32x16_bf16 v[48:63], a[200:203], v[100:103], v[48:63]
    v_mfma_f32_32x32x16_bf16 v[64:79], a[232:235], v[100:103], v[64:79]
    buffer_load_dwordx4 v1, s[40:43], s36 offen offset:2048 sc1 lds
    s_mul_i32 s82, s82, 12288
    s_add_u32 s82, s82, 106496
    v_add_u32 v14, s82, v1
    s_mul_i32 s82, s20, 12288
    s_add_u32 s82, s82, 98304
    s_waitcnt vmcnt(11)
    v_mfma_f32_32x32x16_bf16 v[16:31], a[204:207], v[104:107], v[16:31]
    v_mfma_f32_32x32x16_bf16 v[32:47], a[236:239], v[104:107], v[32:47]
    v_mfma_f32_32x32x16_bf16 v[48:63], a[204:207], v[108:111], v[48:63]
    v_mfma_f32_32x32x16_bf16 v[64:79], a[236:239], v[108:111], v[64:79]
    buffer_load_dwordx4 v1, s[40:43], s36 offen offset:3072 sc1 lds
    v_add_u32 v15, s82, v1
    v_permlane32_swap_b32 v172, v174
    v_permlane32_swap_b32 v173, v175
    v_permlane32_swap_b32 v176, v178
    s_waitcnt vmcnt(10)
    v_mfma_f32_32x32x16_bf16 v[16:31], a[208:211], v[112:115], v[16:31]
    v_mfma_f32_32x32x16_bf16 v[32:47], a[240:243], v[112:115], v[32:47]
    v_mfma_f32_32x32x16_bf16 v[48:63], a[208:211], v[116:119], v[48:63]
    v_mfma_f32_32x32x16_bf16 v[64:79], a[240:243], v[116:119], v[64:79]
    s_add_u32 s36, s36, 4096
    s_add_u32 s37, s37, 4096
    s_mov_b32 m0, s37
    s_nop 0
    buffer_load_dwordx4 v1, s[40:43], s36 offen offset:0 sc1 lds
    v_permlane32_swap_b32 v177, v179
    s_nop 0
    v_lshlrev_b32 v180, 16, v172
    v_and_b32 v181, 0xffff0000, v172
    v_lshlrev_b32 v182, 16, v173
    s_waitcnt vmcnt(9)
    v_mfma_f32_32x32x16_bf16 v[16:31], a[212:215], v[120:123], v[16:31]
    v_mfma_f32_32x32x16_bf16 v[32:47], a[244:247], v[120:123], v[32:47]
    v_mfma_f32_32x32x16_bf16 v[48:63], a[212:215], v[124:127], v[48:63]
    v_mfma_f32_32x32x16_bf16 v[64:79], a[244:247], v[124:127], v[64:79]
    buffer_load_dwordx4 v1, s[40:43], s36 offen offset:1024 sc1 lds
    v_and_b32 v183, 0xffff0000, v173
    v_lshlrev_b32 v184, 16, v174
    v_and_b32 v185, 0xffff0000, v174
    v_lshlrev_b32 v186, 16, v175
    s_waitcnt vmcnt(8)
    v_mfma_f32_32x32x16_bf16 v[16:31], a[216:219], v[128:131], v[16:31]
    v_mfma_f32_32x32x16_bf16 v[32:47], a[248:251], v[128:131], v[32:47]
    v_mfma_f32_32x32x16_bf16 v[48:63], a[216:219], v[132:135], v[48:63]
    v_mfma_f32_32x32x16_bf16 v[64:79], a[248:251], v[132:135], v[64:79]
    buffer_load_dwordx4 v1, s[40:43], s36 offen offset:2048 sc1 lds
    v_and_b32 v187, 0xffff0000, v175
    v_lshlrev_b32 v188, 16, v176
    v_and_b32 v189, 0xffff0000, v176
    v_lshlrev_b32 v190, 16, v177
    v_and_b32 v191, 0xffff0000, v177
    s_waitcnt vmcnt(7)
    v_mfma_f32_32x32x16_bf16 v[16:31], a[220:223], v[136:139], v[16:31]
    v_mfma_f32_32x32x16_bf16 v[32:47], a[252:255], v[136:139], v[32:47]
    v_mfma_f32_32x32x16_bf16 v[48:63], a[220:223], v[140:143], v[48:63]
    v_mfma_f32_32x32x16_bf16 v[64:79], a[252:255], v[140:143], v[64:79]
    buffer_load_dwordx4 v1, s[40:43], s36 offen offset:3072 sc1 lds
    s_add_u32 s36, s36, 28672
    s_add_u32 s37, s37, 28672
    s_and_b32 s37, s37, 0x1ffff
    v_lshlrev_b32 v192, 16, v178
    v_and_b32 v193, 0xffff0000, v178
    v_lshlrev_b32 v194, 16, v179
    v_and_b32 v195, 0xffff0000, v179
    s_cmp_lg_u32 s20, 0
    s_cbranch_scc1 L_fs_33
    s_mov_b32 s29, 0
L_fp_31:
    v_cmp_ne_u32 vcc, s23, v150
    s_cbranch_vccz L_fe_32
    s_add_u32 s29, s29, 1
    s_cmp_ge_u32 s29, 32768
    s_cbranch_scc1 L_fe_32
    buffer_load_dword v150, v151, s[8:11], 0 offen sc1
    s_waitcnt vmcnt(0)
    s_branch L_fp_31
L_fe_32:
L_fs_33:
    s_nop 7
    s_nop 1
    ds_write_b128 v12, v[32:35] offset:0
    ds_write_b128 v12, v[36:39] offset:1024
    ds_write_b128 v12, v[40:43] offset:2048
    ds_write_b128 v12, v[44:47] offset:3072
    ds_write_b128 v13, v[48:51] offset:0
    ds_write_b128 v13, v[52:55] offset:1024
    ds_write_b128 v13, v[56:59] offset:2048
    ds_write_b128 v13, v[60:63] offset:3072
    ds_write_b128 v14, v[64:67] offset:0
    ds_write_b128 v14, v[68:71] offset:1024
    ds_write_b128 v14, v[72:75] offset:2048
    ds_write_b128 v14, v[76:79] offset:3072
    v_pk_add_f32 v[16:17], v[16:17], v[180:181]
    v_pk_add_f32 v[18:19], v[18:19], v[182:183]
    v_pk_add_f32 v[20:21], v[20:21], v[184:185]
    v_pk_add_f32 v[22:23], v[22:23], v[186:187]
    v_pk_add_f32 v[24:25], v[24:25], v[188:189]
    v_pk_add_f32 v[26:27], v[26:27], v[190:191]
    v_pk_add_f32 v[28:29], v[28:29], v[192:193]
    v_pk_add_f32 v[30:31], v[30:31], v[194:195]
    s_waitcnt lgkmcnt(0)
    s_barrier
    ds_read_b128 v[80:83], v15 offset:0
    ds_read_b128 v[84:87], v15 offset:1024
    ds_read_b128 v[88:91], v15 offset:2048
    ds_read_b128 v[92:95], v15 offset:3072
    ds_read_b128 v[96:99], v15 offset:4096
    ds_read_b128 v[100:103], v15 offset:5120
    ds_read_b128 v[104:107], v15 offset:6144
    ds_read_b128 v[108:111], v15 offset:7168
    ds_read_b128 v[112:115], v15 offset:8192
    ds_read_b128 v[116:119], v15 offset:9216
    ds_read_b128 v[120:123], v15 offset:10240
    ds_read_b128 v[124:127], v15 offset:11264
    s_waitcnt lgkmcnt(8)
    v_pk_add_f32 v[16:17], v[16:17], v[80:81]
    v_pk_add_f32 v[18:19], v[18:19], v[82:83]
    v_pk_add_f32 v[20:21], v[20:21], v[84:85]
    v_pk_add_f32 v[22:23], v[22:23], v[86:87]
    v_pk_add_f32 v[24:25], v[24:25], v[88:89]
    v_pk_add_f32 v[26:27], v[26:27], v[90:91]
    v_pk_add_f32 v[28:29], v[28:29], v[92:93]
    v_pk_add_f32 v[30:31], v[30:31], v[94:95]
    s_waitcnt lgkmcnt(4)
    v_pk_add_f32 v[16:17], v[16:17], v[96:97]
    v_pk_add_f32 v[18:19], v[18:19], v[98:99]
    v_pk_add_f32 v[20:21], v[20:21], v[100:101]
    v_pk_add_f32 v[22:23], v[22:23], v[102:103]
    v_pk_add_f32 v[24:25], v[24:25], v[104:105]
    v_pk_add_f32 v[26:27], v[26:27], v[106:107]
    v_pk_add_f32 v[28:29], v[28:29], v[108:109]
    v_pk_add_f32 v[30:31], v[30:31], v[110:111]
    s_waitcnt lgkmcnt(0)
    v_pk_add_f32 v[16:17], v[16:17], v[112:113]
    v_pk_add_f32 v[18:19], v[18:19], v[114:115]
    v_pk_add_f32 v[20:21], v[20:21], v[116:117]
    v_pk_add_f32 v[22:23], v[22:23], v[118:119]
    v_pk_add_f32 v[24:25], v[24:25], v[120:121]
    v_pk_add_f32 v[26:27], v[26:27], v[122:123]
    v_pk_add_f32 v[28:29], v[28:29], v[124:125]
    v_pk_add_f32 v[30:31], v[30:31], v[126:127]
    v_cvt_pk_bf16_f32 v240, v16, v17
    v_cvt_pk_bf16_f32 v241, v18, v19
    v_cvt_pk_bf16_f32 v242, v20, v21
    v_cvt_pk_bf16_f32 v243, v22, v23
    v_cvt_pk_bf16_f32 v244, v24, v25
    v_cvt_pk_bf16_f32 v245, v26, v27
    v_cvt_pk_bf16_f32 v246, v28, v29
    v_cvt_pk_bf16_f32 v247, v30, v31
    s_lshl_b32 s38, s31, 15
    s_lshl_b32 s39, s30, 11
    s_add_u32 s38, s38, s39
    s_add_u32 s38, s38, 0x200000
    buffer_store_dwordx4 v[240:243], v1, s[72:75], s38 offen sc1
    buffer_store_dwordx4 v[240:243], v1, s[76:79], s38 offen
    buffer_store_dwordx4 v[244:247], v1, s[72:75], s38 offen offset:1024 sc1
    buffer_store_dwordx4 v[244:247], v1, s[76:79], s38 offen offset:1024
    v_mov_b32 v32, 0
    v_mov_b32 v33, 0
    v_dot2c_f32_bf16 v32, v240, v239
    v_dot2c_f32_bf16 v33, v240, v240
    v_dot2c_f32_bf16 v32, v241, v239
    v_dot2c_f32_bf16 v33, v241, v241
    v_dot2c_f32_bf16 v32, v242, v239
    v_dot2c_f32_bf16 v33, v242, v242
    v_dot2c_f32_bf16 v32, v243, v239
    v_dot2c_f32_bf16 v33, v243, v243
    v_dot2c_f32_bf16 v32, v244, v239
    v_dot2c_f32_bf16 v33, v244, v244
    v_dot2c_f32_bf16 v32, v245, v239
    v_dot2c_f32_bf16 v33, v245, v245
    v_dot2c_f32_bf16 v32, v246, v239
    v_dot2c_f32_bf16 v33, v246, v246
    v_dot2c_f32_bf16 v32, v247, v239
    v_dot2c_f32_bf16 v33, v247, v247
    s_nop 2
    v_mov_b32 v36, v32
    v_mov_b32 v37, v33
    s_nop 1
    v_permlane32_swap_b32 v32, v36
    v_permlane32_swap_b32 v33, v37
    s_nop 0
    v_pk_add_f32 v[32:33], v[32:33], v[36:37]
    s_lshl_b32 s38, s31, 12
    s_bfe_u32 s39, s30, 0x20001
    s_lshl_b32 s39, s39, 10
    s_add_u32 s38, s38, s39
    s_lshr_b32 s39, s30, 3
    s_lshl_b32 s39, s39, 9
    s_add_u32 s38, s38, s39
    s_and_b32 s39, s30, 1
    s_lshl_b32 s39, s39, 3
    s_add_u32 s38, s38, s39
    s_add_u32 s38, s38, 0x400000
    v_and_b32 v12, 31, v0
    v_lshlrev_b32 v12, 4, v12
    buffer_store_dwordx2 v[32:33], v12, s[72:75], s38 offen sc1
    buffer_store_dwordx2 v[32:33], v12, s[76:79], s38 offen
    buffer_load_dwordx4 a[0:3], v7, s[8:11], s52 offen offset:0 sc1
    buffer_load_dwordx4 a[112:115], v8, s[8:11], s52 offen offset:0 sc1
    buffer_load_dwordx4 a[4:7], v7, s[8:11], s52 offen offset:1024 sc1
    buffer_load_dwordx4 a[116:119], v8, s[8:11], s52 offen offset:1024 sc1
    buffer_load_dwordx4 a[8:11], v7, s[8:11], s52 offen offset:2048 sc1
    buffer_load_dwordx4 a[120:123], v8, s[8:11], s52 offen offset:2048 sc1
    buffer_load_dwordx4 a[12:15], v7, s[8:11], s52 offen offset:3072 sc1
    buffer_load_dwordx4 a[124:127], v8, s[8:11], s52 offen offset:3072 sc1
    s_waitcnt vmcnt(8)
    s_barrier
    s_lshl_b32 s27, s21, 7
    s_lshl_b32 s28, s22, 2
    s_add_u32 s27, s27, s28
    s_add_u32 s27, s27, 0x1300c00
    s_cmp_lg_u32 s20, 0
    s_cbranch_scc1 L_fs_34
    v_mov_b32 v12, s23
    v_mov_b32 v13, 0
    s_mov_b64 exec, 1
    buffer_store_dword v12, v13, s[72:75], s27 offen sc1
    buffer_store_dword v12, v13, s[76:79], s27 offen
    s_mov_b64 exec, -1
L_fs_34:
    s_mov_b32 m0, s37
    s_nop 0
    buffer_load_dwordx4 v1, s[40:43], s36 offen offset:0 sc1 lds
    buffer_load_dwordx4 v1, s[40:43], s36 offen offset:1024 sc1 lds
    buffer_load_dwordx4 v1, s[40:43], s36 offen offset:2048 sc1 lds
    buffer_load_dwordx4 v1, s[40:43], s36 offen offset:3072 sc1 lds
    s_add_u32 s36, s36, 4096
    s_add_u32 s37, s37, 4096
    s_mov_b32 m0, s37
    s_nop 0
    buffer_load_dwordx4 v1, s[40:43], s36 offen offset:0 sc1 lds
    buffer_load_dwordx4 v1, s[40:43], s36 offen offset:1024 sc1 lds
    buffer_load_dwordx4 v1, s[40:43], s36 offen offset:2048 sc1 lds
    buffer_load_dwordx4 v1, s[40:43], s36 offen offset:3072 sc1 lds
    s_add_u32 s36, s36, 28672
    s_add_u32 s37, s37, 28672
    s_and_b32 s37, s37, 0x1ffff
    v_and_b32 v12, 15, v2
    v_lshlrev_b32 v12, 2, v12
    s_lshl_b32 s27, s21, 7
    s_add_u32 s27, s27, 0x1300c00
    s_cmp_lg_u32 s20, 0
    s_cbranch_scc1 L_wp_35
    s_mov_b32 s29, 0
L_poll_36:
    buffer_load_dword v13, v12, s[8:11], s27 offen sc1
    s_add_u32 s29, s29, 1
    s_cmp_ge_u32 s29, 32768
    s_waitcnt vmcnt(0)
    s_cbranch_scc1 L_pd_37
    v_cmp_ne_u32 vcc, s23, v13
    s_cbranch_vccnz L_poll_36
L_pd_37:
L_wp_35:
    s_waitcnt vmcnt(0)
    s_barrier
    s_xor_b32 s38, s30, 1
    s_mul_i32 s39, s20, 28672
    s_mul_i32 s82, s30, 114688
    s_add_u32 s82, s82, s39
    s_add_u32 s82, s82, 0x884000
    s_add_u32 s80, s82, 4096
    s_mul_i32 s81, s38, 114688
    s_add_u32 s81, s81, s39
    s_add_u32 s81, s81, 0x885000
    s_lshl_b32 s47, s21, 2
    s_add_u32 s47, s47, s20
    s_lshl_b32 s38, s47, 12
    s_add_u32 s38, s38, 0x400000
    s_lshl_b32 s46, s47, 15
    s_add_u32 s46, s46, 0x200000
    buffer_load_dwordx4 v[204:207], v1, s[8:11], s38 offen offset:0 sc1
    buffer_load_dwordx4 v[208:211], v1, s[8:11], s38 offen offset:1024 sc1
    buffer_load_dwordx4 v[212:215], v1, s[8:11], s38 offen offset:2048 sc1
    buffer_load_dwordx4 v[216:219], v1, s[8:11], s38 offen offset:3072 sc1
    buffer_load_dwordx4 v[12:15], v1, s[8:11], s46 offen sc1
    buffer_load_dwordx4 v[16:19], v1, s[8:11], s46 offen offset:1024 sc1
    buffer_load_dwordx4 v[20:23], v1, s[8:11], s46 offen offset:2048 sc1
    buffer_load_dwordx4 v[24:27], v1, s[8:11], s46 offen offset:3072 sc1
    s_add_u32 s46, s46, 4096
    buffer_load_dwordx4 v[28:31], v1, s[8:11], s46 offen sc1
    buffer_load_dwordx4 v[32:35], v1, s[8:11], s46 offen offset:1024 sc1
    buffer_load_dwordx4 v[36:39], v1, s[8:11], s46 offen offset:2048 sc1
    buffer_load_dwordx4 v[40:43], v1, s[8:11], s46 offen offset:3072 sc1
    s_add_u32 s46, s46, 4096
    buffer_load_dwordx4 v[44:47], v1, s[8:11], s46 offen sc1
    buffer_load_dwordx4 v[48:51], v1, s[8:11], s46 offen offset:1024 sc1
    buffer_load_dwordx4 v[52:55], v1, s[8:11], s46 offen offset:2048 sc1
    buffer_load_dwordx4 v[56:59], v1, s[8:11], s46 offen offset:3072 sc1
    s_add_u32 s46, s46, 4096
    buffer_load_dwordx4 v[60:63], v1, s[8:11], s46 offen sc1
    buffer_load_dwordx4 v[64:67], v1, s[8:11], s46 offen offset:1024 sc1
    buffer_load_dwordx4 v[68:71], v1, s[8:11], s46 offen offset:2048 sc1
    buffer_load_dwordx4 v[72:75], v1, s[8:11], s46 offen offset:3072 sc1
    s_add_u32 s46, s46, 4096
    s_mul_i32 s45, s47, 114688
    s_mul_i32 s39, s22, 7168
    s_add_u32 s45, s45, s39
    s_add_u32 s45, s45, 0xb00000
    v_mov_b32 v3, v1
    v_add_u32 v4, 32768, v1
    v_bfe_u32 v5, v0, 5, 1
    v_lshlrev_b32 v5, 4, v5
    v_add_u32 v5, 147456, v5
    s_mov_b32 s68, s8
    s_mov_b32 s69, s9
    s_mov_b32 s70, 0
    s_mov_b32 s71, 0x20000
    s_mov_b32 s48, s36
    s_lshl_b32 s49, s20, 12
    s_add_u32 s49, s49, 131072
    ds_read_b128 v[172:175], v3 offset:0
    ds_read_b128 v[176:179], v3 offset:1024
    ds_read_b128 v[180:183], v3 offset:2048
    ds_read_b128 v[184:187], v3 offset:3072
    ds_read_b128 v[188:191], v3 offset:4096
    ds_read_b128 v[192:195], v3 offset:5120
    s_waitcnt vmcnt(16)
    v_add_f32 v236, v204, v206
    v_add_f32 v237, v205, v207
    v_add_f32 v236, v236, v208
    v_add_f32 v237, v237, v209
    v_add_f32 v236, v236, v210
    v_add_f32 v237, v237, v211
    v_add_f32 v236, v236, v212
    v_add_f32 v237, v237, v213
    v_add_f32 v236, v236, v214
    v_add_f32 v237, v237, v215
    v_add_f32 v236, v236, v216
    v_add_f32 v237, v237, v217
    v_add_f32 v236, v236, v218
    v_add_f32 v237, v237, v219
    v_mov_b32 v228, v236
    v_mov_b32 v229, v237
    s_nop 1
    v_permlane32_swap_b32 v236, v228
    v_permlane32_swap_b32 v237, v229
    s_nop 0
    v_add_f32 v236, v236, v228
    v_add_f32 v237, v237, v229
    v_mul_f32 v236, 0x3b000000, v236
    v_mul_f32 v237, 0x3b000000, v237
    v_fma_f32 v237, -v236, v236, v237
    v_add_f32 v237, 0x3727c5ac, v237
    v_rsq_f32 v10, v237
    s_nop 0
    v_mul_f32 v6, 0xbfb8aa3b, v10
    v_mul_f32 v11, v236, v10
    v_mul_f32 v9, 0x3fb8aa3b, v11
    v_sub_f32 v11, 0, v11
    v_add_u32 v238, 65536, v1
    ds_read_b128 v[204:207], v4 offset:0
    ds_read_b128 v[208:211], v4 offset:1024
    ds_read_b128 v[212:215], v4 offset:2048
    ds_read_b128 v[216:219], v4 offset:3072
    ds_read_b128 v[220:223], v4 offset:4096
    ds_read_b128 v[224:227], v4 offset:5120
    s_waitcnt vmcnt(15) lgkmcnt(5)
    v_mfma_f32_32x32x16_bf16 v[140:155], v[172:175], v[12:15], 0
    v_mfma_f32_32x32x16_bf16 a[224:239], v[204:207], v[12:15], 0
    ds_read_b128 v[196:199], v3 offset:6144
    ds_read_b128 v[228:231], v4 offset:6144
    buffer_load_dwordx4 v[76:79], v1, s[8:11], s46 offen sc1
    s_waitcnt vmcnt(15) lgkmcnt(6)
    v_mfma_f32_32x32x16_bf16 v[140:155], v[176:179], v[16:19], v[140:155]
    v_mfma_f32_32x32x16_bf16 a[224:239], v[208:211], v[16:19], a[224:239]
    ds_read_b128 v[200:203], v3 offset:7168
    ds_read_b128 v[232:235], v4 offset:7168
    buffer_load_dwordx4 v[80:83], v1, s[8:11], s46 offen offset:1024 sc1
    s_waitcnt vmcnt(15) lgkmcnt(7)
    v_mfma_f32_32x32x16_bf16 v[140:155], v[180:183], v[20:23], v[140:155]
    v_mfma_f32_32x32x16_bf16 a[224:239], v[212:215], v[20:23], a[224:239]
    ds_read_b128 v[172:175], v3 offset:8192
    ds_read_b128 v[204:207], v4 offset:8192
    buffer_load_dwordx4 v[84:87], v1, s[8:11], s46 offen offset:2048 sc1
    s_waitcnt vmcnt(15) lgkmcnt(8)
    v_mfma_f32_32x32x16_bf16 v[140:155], v[184:187], v[24:27], v[140:155]
    v_mfma_f32_32x32x16_bf16 a[224:239], v[216:219], v[24:27], a[224:239]
    ds_read_b128 v[176:179], v3 offset:9216
    ds_read_b128 v[208:211], v4 offset:9216
    buffer_load_dwordx4 v[88:91], v1, s[8:11], s46 offen offset:3072 sc1
    s_add_u32 s46, s46, 4096
    s_waitcnt vmcnt(15) lgkmcnt(9)
    v_mfma_f32_32x32x16_bf16 v[140:155], v[188:191], v[28:31], v[140:155]
    v_mfma_f32_32x32x16_bf16 a[224:239], v[220:223], v[28:31], a[224:239]
    ds_read_b128 v[180:183], v3 offset:10240
    ds_read_b128 v[212:215], v4 offset:10240
    buffer_load_dwordx4 v[92:95], v1, s[8:11], s46 offen sc1
    s_waitcnt vmcnt(15) lgkmcnt(10)
    v_mfma_f32_32x32x16_bf16 v[140:155], v[192:195], v[32:35], v[140:155]
    v_mfma_f32_32x32x16_bf16 a[224:239], v[224:227], v[32:35], a[224:239]
    ds_read_b128 v[184:187], v3 offset:11264
    ds_read_b128 v[216:219], v4 offset:11264
    buffer_load_dwordx4 v[96:99], v1, s[8:11], s46 offen offset:1024 sc1
    s_waitcnt vmcnt(15) lgkmcnt(10)
    v_mfma_f32_32x32x16_bf16 v[140:155], v[196:199], v[36:39], v[140:155]
    v_mfma_f32_32x32x16_bf16 a[224:239], v[228:231], v[36:39], a[224:239]
    ds_read_b128 v[188:191], v3 offset:12288
    ds_read_b128 v[220:223], v4 offset:12288
    buffer_load_dwordx4 v[100:103], v1, s[8:11], s46 offen offset:2048 sc1
    s_waitcnt vmcnt(15) lgkmcnt(10)
    v_mfma_f32_32x32x16_bf16 v[140:155], v[200:203], v[40:43], v[140:155]
    v_mfma_f32_32x32x16_bf16 a[224:239], v[232:235], v[40:43], a[224:239]
    ds_read_b128 v[192:195], v3 offset:13312
    ds_read_b128 v[224:227], v4 offset:13312
    buffer_load_dwordx4 v[104:107], v1, s[8:11], s46 offen offset:3072 sc1
    s_add_u32 s46, s46, 4096
    s_waitcnt vmcnt(15) lgkmcnt(10)
    v_mfma_f32_32x32x16_bf16 v[140:155], v[172:175], v[44:47], v[140:155]
    v_mfma_f32_32x32x16_bf16 a[224:239], v[204:207], v[44:47], a[224:239]
    ds_read_b128 v[196:199], v3 offset:14336
    ds_read_b128 v[228:231], v4 offset:14336
    buffer_load_dwordx4 v[108:111], v1, s[8:11], s46 offen sc1
    s_waitcnt vmcnt(15) lgkmcnt(10)
    v_mfma_f32_32x32x16_bf16 v[140:155], v[176:179], v[48:51], v[140:155]
    v_mfma_f32_32x32x16_bf16 a[224:239], v[208:211], v[48:51], a[224:239]
    ds_read_b128 v[200:203], v3 offset:15360
    ds_read_b128 v[232:235], v4 offset:15360
    buffer_load_dwordx4 v[112:115], v1, s[8:11], s46 offen offset:1024 sc1
    s_waitcnt vmcnt(15) lgkmcnt(10)
    v_mfma_f32_32x32x16_bf16 v[140:155], v[180:183], v[52:55], v[140:155]
    v_mfma_f32_32x32x16_bf16 a[224:239], v[212:215], v[52:55], a[224:239]
    ds_read_b128 v[172:175], v3 offset:16384
    ds_read_b128 v[204:207], v4 offset:16384
    buffer_load_dwordx4 v[116:119], v1, s[8:11], s46 offen offset:2048 sc1
    s_waitcnt vmcnt(15) lgkmcnt(10)
    v_mfma_f32_32x32x16_bf16 v[140:155], v[184:187], v[56:59], v[140:155]
    v_mfma_f32_32x32x16_bf16 a[224:239], v[216:219], v[56:59], a[224:239]
    ds_read_b128 v[176:179], v3 offset:17408
    ds_read_b128 v[208:211], v4 offset:17408
    buffer_load_dwordx4 v[120:123], v1, s[8:11], s46 offen offset:3072 sc1
    s_add_u32 s46, s46, 4096
    s_waitcnt vmcnt(15) lgkmcnt(10)
    v_mfma_f32_32x32x16_bf16 v[140:155], v[188:191], v[60:63], v[140:155]
    v_mfma_f32_32x32x16_bf16 a[224:239], v[220:223], v[60:63], a[224:239]
    ds_read_b128 v[180:183], v3 offset:18432
    ds_read_b128 v[212:215], v4 offset:18432
    buffer_load_dwordx4 v[124:127], v1, s[8:11], s46 offen sc1
    s_waitcnt vmcnt(15) lgkmcnt(10)
    v_mfma_f32_32x32x16_bf16 v[140:155], v[192:195], v[64:67], v[140:155]
    v_mfma_f32_32x32x16_bf16 a[224:239], v[224:227], v[64:67], a[224:239]
    ds_read_b128 v[184:187], v3 offset:19456
    ds_read_b128 v[216:219], v4 offset:19456
    buffer_load_dwordx4 v[128:131], v1, s[8:11], s46 offen offset:1024 sc1
    s_waitcnt vmcnt(15) lgkmcnt(10)
    v_mfma_f32_32x32x16_bf16 v[140:155], v[196:199], v[68:71], v[140:155]
    v_mfma_f32_32x32x16_bf16 a[224:239], v[228:231], v[68:71], a[224:239]
    ds_read_b128 v[188:191], v3 offset:20480
    ds_read_b128 v[220:223], v4 offset:20480
    buffer_load_dwordx4 v[132:135], v1, s[8:11], s46 offen offset:2048 sc1
    s_waitcnt vmcnt(15) lgkmcnt(10)
    v_mfma_f32_32x32x16_bf16 v[140:155], v[200:203], v[72:75], v[140:155]
    v_mfma_f32_32x32x16_bf16 a[224:239], v[232:235], v[72:75], a[224:239]
    ds_read_b128 v[192:195], v3 offset:21504
    ds_read_b128 v[224:227], v4 offset:21504
    buffer_load_dwordx4 v[136:139], v1, s[8:11], s46 offen offset:3072 sc1
    s_add_u32 s46, s46, 4096
    s_waitcnt vmcnt(15) lgkmcnt(10)
    v_mfma_f32_32x32x16_bf16 v[140:155], v[172:175], v[76:79], v[140:155]
    v_mfma_f32_32x32x16_bf16 a[224:239], v[204:207], v[76:79], a[224:239]
    ds_read_b128 v[196:199], v3 offset:22528
    ds_read_b128 v[228:231], v4 offset:22528
    buffer_load_dwordx4 a[16:19], v7, s[8:11], s53 offen offset:0 sc1
    s_waitcnt vmcnt(15) lgkmcnt(10)
    v_mfma_f32_32x32x16_bf16 v[140:155], v[176:179], v[80:83], v[140:155]
    v_mfma_f32_32x32x16_bf16 a[224:239], v[208:211], v[80:83], a[224:239]
    ds_read_b128 v[200:203], v3 offset:23552
    ds_read_b128 v[232:235], v4 offset:23552
    buffer_load_dwordx4 a[128:131], v8, s[8:11], s53 offen offset:0 sc1
    s_waitcnt vmcnt(15) lgkmcnt(10)
    v_mfma_f32_32x32x16_bf16 v[140:155], v[180:183], v[84:87], v[140:155]
    v_mfma_f32_32x32x16_bf16 a[224:239], v[212:215], v[84:87], a[224:239]
    ds_read_b128 v[172:175], v3 offset:24576
    ds_read_b128 v[204:207], v4 offset:24576
    buffer_load_dwordx4 a[20:23], v7, s[8:11], s53 offen offset:1024 sc1
    s_waitcnt vmcnt(15) lgkmcnt(10)
    v_mfma_f32_32x32x16_bf16 v[140:155], v[184:187], v[88:91], v[140:155]
    v_mfma_f32_32x32x16_bf16 a[224:239], v[216:219], v[88:91], a[224:239]
    ds_read_b128 v[176:179], v3 offset:25600
    ds_read_b128 v[208:211], v4 offset:25600
    buffer_load_dwordx4 a[132:135], v8, s[8:11], s53 offen offset:1024 sc1
    s_waitcnt vmcnt(15) lgkmcnt(10)
    v_mfma_f32_32x32x16_bf16 v[140:155], v[188:191], v[92:95], v[140:155]
    v_mfma_f32_32x32x16_bf16 a[224:239], v[220:223], v[92:95], a[224:239]
    ds_read_b128 v[180:183], v3 offset:26624
    ds_read_b128 v[212:215], v4 offset:26624
    buffer_load_dwordx4 a[24:27], v7, s[8:11], s53 offen offset:2048 sc1
    s_waitcnt vmcnt(15) lgkmcnt(10)
    v_mfma_f32_32x32x16_bf16 v[140:155], v[192:195], v[96:99], v[140:155]
    v_mfma_f32_32x32x16_bf16 a[224:239], v[224:227], v[96:99], a[224:239]
    ds_read_b128 v[184:187], v3 offset:27648
    ds_read_b128 v[216:219], v4 offset:27648
    buffer_load_dwordx4 a[136:139], v8, s[8:11], s53 offen offset:2048 sc1
    s_waitcnt vmcnt(15) lgkmcnt(10)
    v_mfma_f32_32x32x16_bf16 v[140:155], v[196:199], v[100:103], v[140:155]
    v_mfma_f32_32x32x16_bf16 a[224:239], v[228:231], v[100:103], a[224:239]
    ds_read_b128 v[188:191], v3 offset:28672
    ds_read_b128 v[220:223], v4 offset:28672
    buffer_load_dwordx4 a[28:31], v7, s[8:11], s53 offen offset:3072 sc1
    s_waitcnt vmcnt(15) lgkmcnt(10)
    v_mfma_f32_32x32x16_bf16 v[140:155], v[200:203], v[104:107], v[140:155]
    v_mfma_f32_32x32x16_bf16 a[224:239], v[232:235], v[104:107], a[224:239]
    ds_read_b128 v[192:195], v3 offset:29696
    ds_read_b128 v[224:227], v4 offset:29696
    buffer_load_dwordx4 a[140:143], v8, s[8:11], s53 offen offset:3072 sc1
    s_waitcnt vmcnt(15) lgkmcnt(10)
    v_mfma_f32_32x32x16_bf16 v[140:155], v[172:175], v[108:111], v[140:155]
    v_mfma_f32_32x32x16_bf16 a[224:239], v[204:207], v[108:111], a[224:239]
    ds_read_b128 v[196:199], v3 offset:30720
    ds_read_b128 v[228:231], v4 offset:30720
    buffer_load_dwordx4 a[32:35], v7, s[8:11], s54 offen offset:0 sc1
    s_waitcnt vmcnt(15) lgkmcnt(10)
    v_mfma_f32_32x32x16_bf16 v[140:155], v[176:179], v[112:115], v[140:155]
    v_mfma_f32_32x32x16_bf16 a[224:239], v[208:211], v[112:115], a[224:239]
    ds_read_b128 v[200:203], v3 offset:31744
    ds_read_b128 v[232:235], v4 offset:31744
    buffer_load_dwordx4 a[144:147], v8, s[8:11], s54 offen offset:0 sc1
    s_waitcnt vmcnt(15) lgkmcnt(10)
    v_mfma_f32_32x32x16_bf16 v[140:155], v[180:183], v[116:119], v[140:155]
    v_mfma_f32_32x32x16_bf16 a[224:239], v[212:215], v[116:119], a[224:239]
    ds_read_b128 v[172:175], v238 offset:0
    buffer_load_dwordx4 a[36:39], v7, s[8:11], s54 offen offset:1024 sc1
    s_waitcnt vmcnt(15) lgkmcnt(9)
    v_mfma_f32_32x32x16_bf16 v[140:155], v[184:187], v[120:123], v[140:155]
    v_mfma_f32_32x32x16_bf16 a[224:239], v[216:219], v[120:123], a[224:239]
    ds_read_b128 v[176:179], v238 offset:1024
    buffer_load_dwordx4 a[148:151], v8, s[8:11], s54 offen offset:1024 sc1
    s_waitcnt vmcnt(15) lgkmcnt(8)
    v_mfma_f32_32x32x16_bf16 v[140:155], v[188:191], v[124:127], v[140:155]
    v_mfma_f32_32x32x16_bf16 a[224:239], v[220:223], v[124:127], a[224:239]
    ds_read_b128 v[180:183], v238 offset:2048
    buffer_load_dwordx4 a[40:43], v7, s[8:11], s54 offen offset:2048 sc1
    s_waitcnt vmcnt(15) lgkmcnt(7)
    v_mfma_f32_32x32x16_bf16 v[140:155], v[192:195], v[128:131], v[140:155]
    v_mfma_f32_32x32x16_bf16 a[224:239], v[224:227], v[128:131], a[224:239]
    ds_read_b128 v[184:187], v238 offset:3072
    buffer_load_dwordx4 a[152:155], v8, s[8:11], s54 offen offset:2048 sc1
    s_waitcnt vmcnt(15) lgkmcnt(6)
    v_mfma_f32_32x32x16_bf16 v[140:155], v[196:199], v[132:135], v[140:155]
    v_mfma_f32_32x32x16_bf16 a[224:239], v[228:231], v[132:135], a[224:239]
    ds_read_b128 v[188:191], v238 offset:4096
    buffer_load_dwordx4 a[44:47], v7, s[8:11], s54 offen offset:3072 sc1
    s_waitcnt vmcnt(15) lgkmcnt(5)
    v_mfma_f32_32x32x16_bf16 v[156:171], v[200:203], v[136:139], v[140:155]
    v_mfma_f32_32x32x16_bf16 a[224:239], v[232:235], v[136:139], a[224:239]
    ds_read_b128 v[192:195], v238 offset:5120
    buffer_load_dwordx4 a[156:159], v8, s[8:11], s54 offen offset:3072 sc1
    v_mov_b32 v3, v238
    v_add_u32 v4, 32768, v238
    s_waitcnt lgkmcnt(4)
    v_mfma_f32_32x32x16_bf16 v[140:155], v[172:175], v[12:15], 0
    s_barrier
    ds_read_b128 v[204:207], v5 offset:0
    ds_read_b128 v[208:211], v5 offset:32
    ds_read_b128 v[212:215], v5 offset:64
    ds_read_b128 v[216:219], v5 offset:96
    ds_read_b128 v[196:199], v3 offset:6144
    v_mfma_f32_32x32x16_bf16 v[140:155], v[176:179], v[16:19], v[140:155]
    ds_read_b128 v[200:203], v3 offset:7168
    s_mov_b32 m0, s37
    s_nop 0
    buffer_load_dwordx4 v1, s[8:11], s36 offen offset:0 sc1 lds
    s_waitcnt lgkmcnt(8)
    v_mfma_f32_32x32x16_bf16 v[140:155], v[180:183], v[20:23], v[140:155]
    ds_read_b128 v[172:175], v3 offset:8192
    buffer_load_dwordx4 a[48:51], v7, s[8:11], s55 offen offset:0 sc1
    s_waitcnt lgkmcnt(3)
    v_mfma_f32_32x32x16_bf16 v[140:155], v[184:187], v[24:27], v[140:155]
    ds_read_b128 v[176:179], v3 offset:9216
    buffer_load_dwordx4 v1, s[8:11], s36 offen offset:1024 sc1 lds
    v_mul_f32 v220, v204, v9
    v_mul_f32 v221, v205, v9
    v_fma_f32 v220, v156, v6, v220
    v_fma_f32 v221, v157, v6, v221
    v_exp_f32 v220, v220
    v_exp_f32 v221, v221
    v_mfma_f32_32x32x16_bf16 v[140:155], v[188:191], v[28:31], v[140:155]
    ds_read_b128 v[180:183], v3 offset:10240
    buffer_load_dwordx4 a[160:163], v8, s[8:11], s55 offen offset:0 sc1
    v_mul_f32 v228, v212, v11
    v_mul_f32 v229, v213, v11
    v_add_f32 v220, 1.0, v220
    v_add_f32 v221, 1.0, v221
    v_rcp_f32 v220, v220
    v_rcp_f32 v221, v221
    v_mfma_f32_32x32x16_bf16 v[140:155], v[192:195], v[32:35], v[140:155]
    ds_read_b128 v[184:187], v3 offset:11264
    buffer_load_dwordx4 v1, s[8:11], s36 offen offset:2048 sc1 lds
    v_fma_f32 v228, v164, v10, v228
    v_fma_f32 v229, v165, v10, v229
    v_mul_f32 v228, v228, v220
    v_mul_f32 v229, v229, v221
    v_cvt_pk_bf16_f32 v248, v228, v229
    s_waitcnt lgkmcnt(4)
    v_mfma_f32_32x32x16_bf16 v[140:155], v[196:199], v[36:39], v[140:155]
    ds_read_b128 v[188:191], v3 offset:12288
    buffer_load_dwordx4 a[52:55], v7, s[8:11], s55 offen offset:1024 sc1
    v_mul_f32 v222, v206, v9
    v_mul_f32 v223, v207, v9
    v_fma_f32 v222, v158, v6, v222
    v_fma_f32 v223, v159, v6, v223
    v_exp_f32 v222, v222
    v_exp_f32 v223, v223
    v_mfma_f32_32x32x16_bf16 v[140:155], v[200:203], v[40:43], v[140:155]
    ds_read_b128 v[192:195], v3 offset:13312
    buffer_load_dwordx4 v1, s[8:11], s36 offen offset:3072 sc1 lds
    v_mul_f32 v230, v214, v11
    v_mul_f32 v231, v215, v11
    v_add_f32 v222, 1.0, v222
    v_add_f32 v223, 1.0, v223
    v_rcp_f32 v222, v222
    s_waitcnt lgkmcnt(4)
    v_mfma_f32_32x32x16_bf16 v[140:155], v[172:175], v[44:47], v[140:155]
    ds_read_b128 v[196:199], v3 offset:14336
    v_rcp_f32 v223, v223
    v_fma_f32 v230, v166, v10, v230
    v_fma_f32 v231, v167, v10, v231
    v_mul_f32 v230, v230, v222
    v_mul_f32 v231, v231, v223
    v_cvt_pk_bf16_f32 v249, v230, v231
    v_mfma_f32_32x32x16_bf16 v[140:155], v[176:179], v[48:51], v[140:155]
    ds_read_b128 v[200:203], v3 offset:15360
    s_add_u32 m0, s37, 4096
    s_add_u32 s48, s36, 4096
    buffer_load_dwordx4 v1, s[8:11], s48 offen offset:0 sc1 lds
    buffer_load_dwordx4 a[164:167], v8, s[8:11], s55 offen offset:1024 sc1
    v_mul_f32 v224, v208, v9
    v_mul_f32 v225, v209, v9
    v_fma_f32 v224, v160, v6, v224
    v_fma_f32 v225, v161, v6, v225
    v_exp_f32 v224, v224
    s_waitcnt lgkmcnt(4)
    v_mfma_f32_32x32x16_bf16 v[140:155], v[180:183], v[52:55], v[140:155]
    ds_read_b128 v[172:175], v3 offset:16384
    v_exp_f32 v225, v225
    v_mul_f32 v232, v216, v11
    v_mul_f32 v233, v217, v11
    v_add_f32 v224, 1.0, v224
    v_add_f32 v225, 1.0, v225
    v_rcp_f32 v224, v224
    v_mfma_f32_32x32x16_bf16 v[140:155], v[184:187], v[56:59], v[140:155]
    ds_read_b128 v[176:179], v3 offset:17408
    buffer_load_dwordx4 v1, s[8:11], s48 offen offset:1024 sc1 lds
    buffer_load_dwordx4 a[56:59], v7, s[8:11], s55 offen offset:2048 sc1
    v_rcp_f32 v225, v225
    v_fma_f32 v232, v168, v10, v232
    v_fma_f32 v233, v169, v10, v233
    v_mul_f32 v232, v232, v224
    v_mul_f32 v233, v233, v225
    v_cvt_pk_bf16_f32 v250, v232, v233
    s_waitcnt lgkmcnt(4)
    v_mfma_f32_32x32x16_bf16 v[140:155], v[188:191], v[60:63], v[140:155]
    ds_read_b128 v[180:183], v3 offset:18432
    v_mul_f32 v226, v210, v9
    v_mul_f32 v227, v211, v9
    v_fma_f32 v226, v162, v6, v226
    v_fma_f32 v227, v163, v6, v227
    v_exp_f32 v226, v226
    v_mfma_f32_32x32x16_bf16 v[140:155], v[192:195], v[64:67], v[140:155]
    ds_read_b128 v[184:187], v3 offset:19456
    buffer_load_dwordx4 v1, s[8:11], s48 offen offset:2048 sc1 lds
    buffer_load_dwordx4 a[168:171], v8, s[8:11], s55 offen offset:2048 sc1
    v_exp_f32 v227, v227
    v_mul_f32 v234, v218, v11
    v_mul_f32 v235, v219, v11
    v_add_f32 v226, 1.0, v226
    v_add_f32 v227, 1.0, v227
    v_rcp_f32 v226, v226
    s_waitcnt lgkmcnt(4)
    v_mfma_f32_32x32x16_bf16 v[140:155], v[196:199], v[68:71], v[140:155]
    ds_read_b128 v[188:191], v3 offset:20480
    v_rcp_f32 v227, v227
    v_fma_f32 v234, v170, v10, v234
    v_fma_f32 v235, v171, v10, v235
    v_mul_f32 v234, v234, v226
    v_mul_f32 v235, v235, v227
    v_mfma_f32_32x32x16_bf16 v[140:155], v[200:203], v[72:75], v[140:155]
    ds_read_b128 v[192:195], v3 offset:21504
    buffer_load_dwordx4 v1, s[8:11], s48 offen offset:3072 sc1 lds
    v_cvt_pk_bf16_f32 v251, v234, v235
    buffer_store_dwordx4 v[248:251], v1, s[8:11], s45 offen sc1
    ds_read_b128 v[204:207], v5 offset:128
    ds_read_b128 v[208:211], v5 offset:160
    ds_read_b128 v[212:215], v5 offset:192
    ds_read_b128 v[216:219], v5 offset:224
    v_accvgpr_read_b32 v156, a224
    v_accvgpr_read_b32 v157, a225
    v_accvgpr_read_b32 v158, a226
    s_waitcnt lgkmcnt(8)
    v_mfma_f32_32x32x16_bf16 v[140:155], v[172:175], v[76:79], v[140:155]
    ds_read_b128 v[196:199], v3 offset:22528
    buffer_load_dwordx4 a[60:63], v7, s[8:11], s55 offen offset:3072 sc1
    v_accvgpr_read_b32 v159, a227
    v_accvgpr_read_b32 v160, a228
    v_accvgpr_read_b32 v161, a229
    v_accvgpr_read_b32 v162, a230
    v_accvgpr_read_b32 v163, a231
    v_mfma_f32_32x32x16_bf16 v[140:155], v[176:179], v[80:83], v[140:155]
    ds_read_b128 v[200:203], v3 offset:23552
    v_accvgpr_read_b32 v164, a232
    v_accvgpr_read_b32 v165, a233
    v_accvgpr_read_b32 v166, a234
    v_accvgpr_read_b32 v167, a235
    v_accvgpr_read_b32 v168, a236
    v_accvgpr_read_b32 v169, a237
    s_waitcnt lgkmcnt(8)
    v_mfma_f32_32x32x16_bf16 v[140:155], v[180:183], v[84:87], v[140:155]
    ds_read_b128 v[172:175], v3 offset:24576
    buffer_load_dwordx4 a[172:175], v8, s[8:11], s55 offen offset:3072 sc1
    v_accvgpr_read_b32 v170, a238
    v_accvgpr_read_b32 v171, a239
    s_waitcnt lgkmcnt(3)
    v_mul_f32 v220, v204, v9
    v_mul_f32 v221, v205, v9
    v_fma_f32 v220, v156, v6, v220
    v_mfma_f32_32x32x16_bf16 v[140:155], v[184:187], v[88:91], v[140:155]
    ds_read_b128 v[176:179], v3 offset:25600
    v_fma_f32 v221, v157, v6, v221
    v_exp_f32 v220, v220
    v_exp_f32 v221, v221
    v_mul_f32 v228, v212, v11
    v_mul_f32 v229, v213, v11
    v_mfma_f32_32x32x16_bf16 v[140:155], v[188:191], v[92:95], v[140:155]
    ds_read_b128 v[180:183], v3 offset:26624
    s_add_u32 s36, s36, 32768
    s_add_u32 s37, s37, 32768
    s_mov_b32 m0, s37
    s_nop 0
    buffer_load_dwordx4 v1, s[8:11], s36 offen offset:0 sc1 lds
    buffer_load_dwordx4 a[176:179], v8, s[8:11], s56 offen offset:0 sc1
    v_add_f32 v220, 1.0, v220
    v_add_f32 v221, 1.0, v221
    v_rcp_f32 v220, v220
    v_rcp_f32 v221, v221
    v_fma_f32 v228, v164, v10, v228
    v_fma_f32 v229, v165, v10, v229
    v_mfma_f32_32x32x16_bf16 v[140:155], v[192:195], v[96:99], v[140:155]
    ds_read_b128 v[184:187], v3 offset:27648
    v_mul_f32 v228, v228, v220
    v_mul_f32 v229, v229, v221
    v_cvt_pk_bf16_f32 v248, v228, v229
    v_mul_f32 v222, v206, v9
    v_mul_f32 v223, v207, v9
    s_waitcnt lgkmcnt(4)
    v_mfma_f32_32x32x16_bf16 v[140:155], v[196:199], v[100:103], v[140:155]
    ds_read_b128 v[188:191], v3 offset:28672
    v_fma_f32 v222, v158, v6, v222
    v_fma_f32 v223, v159, v6, v223
    v_exp_f32 v222, v222
    v_exp_f32 v223, v223
    v_mul_f32 v230, v214, v11
    v_mul_f32 v231, v215, v11
    v_mfma_f32_32x32x16_bf16 v[140:155], v[200:203], v[104:107], v[140:155]
    ds_read_b128 v[192:195], v3 offset:29696
    buffer_load_dwordx4 v1, s[8:11], s36 offen offset:1024 sc1 lds
    buffer_load_dwordx4 a[180:183], v8, s[8:11], s56 offen offset:1024 sc1
    v_add_f32 v222, 1.0, v222
    v_add_f32 v223, 1.0, v223
    v_rcp_f32 v222, v222
    v_rcp_f32 v223, v223
    v_fma_f32 v230, v166, v10, v230
    s_waitcnt lgkmcnt(4)
    v_mfma_f32_32x32x16_bf16 v[140:155], v[172:175], v[108:111], v[140:155]
    ds_read_b128 v[196:199], v3 offset:30720
    v_fma_f32 v231, v167, v10, v231
    v_mul_f32 v230, v230, v222
    v_mul_f32 v231, v231, v223
    v_cvt_pk_bf16_f32 v249, v230, v231
    v_mul_f32 v224, v208, v9
    v_mul_f32 v225, v209, v9
    v_mfma_f32_32x32x16_bf16 v[140:155], v[176:179], v[112:115], v[140:155]
    ds_read_b128 v[200:203], v3 offset:31744
    buffer_load_dwordx4 a[184:187], v8, s[8:11], s56 offen offset:2048 sc1
    v_fma_f32 v224, v160, v6, v224
    v_fma_f32 v225, v161, v6, v225
    v_exp_f32 v224, v224
    v_exp_f32 v225, v225
    v_mul_f32 v232, v216, v11
    v_mul_f32 v233, v217, v11
    s_waitcnt lgkmcnt(4)
    v_mfma_f32_32x32x16_bf16 v[140:155], v[180:183], v[116:119], v[140:155]
    ds_read_b128 v[172:175], v4 offset:0
    buffer_load_dwordx4 v1, s[8:11], s36 offen offset:2048 sc1 lds
    v_add_f32 v224, 1.0, v224
    v_add_f32 v225, 1.0, v225
    v_rcp_f32 v224, v224
    v_rcp_f32 v225, v225
    v_fma_f32 v232, v168, v10, v232
    v_mfma_f32_32x32x16_bf16 v[140:155], v[184:187], v[120:123], v[140:155]
    ds_read_b128 v[176:179], v4 offset:1024
    buffer_load_dwordx4 a[188:191], v8, s[8:11], s56 offen offset:3072 sc1
    v_fma_f32 v233, v169, v10, v233
    v_mul_f32 v232, v232, v224
    v_mul_f32 v233, v233, v225
    v_cvt_pk_bf16_f32 v250, v232, v233
    v_mul_f32 v226, v210, v9
    v_mul_f32 v227, v211, v9
    s_waitcnt lgkmcnt(4)
    v_mfma_f32_32x32x16_bf16 v[140:155], v[188:191], v[124:127], v[140:155]
    ds_read_b128 v[180:183], v4 offset:2048
    v_fma_f32 v226, v162, v6, v226
    v_fma_f32 v227, v163, v6, v227
    v_exp_f32 v226, v226
    v_exp_f32 v227, v227
    v_mul_f32 v234, v218, v11
    v_mfma_f32_32x32x16_bf16 v[140:155], v[192:195], v[128:131], v[140:155]
    ds_read_b128 v[184:187], v4 offset:3072
    buffer_load_dwordx4 v1, s[8:11], s36 offen offset:3072 sc1 lds
    v_mul_f32 v235, v219, v11
    v_add_f32 v226, 1.0, v226
    v_add_f32 v227, 1.0, v227
    v_rcp_f32 v226, v226
    v_rcp_f32 v227, v227
    v_fma_f32 v234, v170, v10, v234
    s_waitcnt lgkmcnt(4)
    v_mfma_f32_32x32x16_bf16 v[140:155], v[196:199], v[132:135], v[140:155]
    ds_read_b128 v[188:191], v4 offset:4096
    v_fma_f32 v235, v171, v10, v235
    v_mul_f32 v234, v234, v226
    v_mul_f32 v235, v235, v227
    v_cvt_pk_bf16_f32 v251, v234, v235
    buffer_store_dwordx4 v[248:251], v1, s[8:11], s45 offen offset:1024 sc1
    v_mfma_f32_32x32x16_bf16 v[156:171], v[200:203], v[136:139], v[140:155]
    ds_read_b128 v[192:195], v4 offset:5120
    s_add_u32 s48, s36, 4096
    s_add_u32 s49, s37, 4096
    s_mov_b32 s70, s10
    s_add_u32 s36, s36, 32768
    s_add_u32 s37, s37, 32768
    s_and_b32 s37, s37, 0x1ffff
    s_mov_b32 s44, 3
    s_add_u32 s45, s45, 2048
    v_mov_b32 v3, v4
    v_add_u32 v4, 32768, v4
    v_and_b32 v4, 0x1ffff, v4
    v_add_u32 v5, 256, v5
L_s3_loop:
    s_cmp_eq_u32 s44, 4
    s_cselect_b32 s36, s80, s36
    s_cmp_eq_u32 s44, 5
    s_cselect_b32 s36, s81, s36
    s_cmp_eq_u32 s44, 6
    s_cselect_b32 s36, s82, s36
    s_waitcnt lgkmcnt(4)
    v_mfma_f32_32x32x16_bf16 v[140:155], v[172:175], v[12:15], 0
    ds_read_b128 v[204:207], v5 offset:0
    ds_read_b128 v[208:211], v5 offset:32
    ds_read_b128 v[212:215], v5 offset:64
    ds_read_b128 v[216:219], v5 offset:96
    ds_read_b128 v[196:199], v3 offset:6144
    v_mfma_f32_32x32x16_bf16 v[140:155], v[176:179], v[16:19], v[140:155]
    ds_read_b128 v[200:203], v3 offset:7168
    s_mov_b32 m0, s49
    s_nop 0
    buffer_load_dwordx4 v1, s[68:71], s48 offen offset:0 sc1 lds
    s_waitcnt lgkmcnt(8)
    v_mfma_f32_32x32x16_bf16 v[140:155], v[180:183], v[20:23], v[140:155]
    ds_read_b128 v[172:175], v3 offset:8192
    v_mfma_f32_32x32x16_bf16 v[140:155], v[184:187], v[24:27], v[140:155]
    ds_read_b128 v[176:179], v3 offset:9216
    s_waitcnt lgkmcnt(8)
    v_mfma_f32_32x32x16_bf16 v[140:155], v[188:191], v[28:31], v[140:155]
    ds_read_b128 v[180:183], v3 offset:10240
    buffer_load_dwordx4 v1, s[68:71], s48 offen offset:1024 sc1 lds
    v_mfma_f32_32x32x16_bf16 v[140:155], v[192:195], v[32:35], v[140:155]
    ds_read_b128 v[184:187], v3 offset:11264
    s_waitcnt lgkmcnt(4)
    v_mfma_f32_32x32x16_bf16 v[140:155], v[196:199], v[36:39], v[140:155]
    ds_read_b128 v[188:191], v3 offset:12288
    v_mfma_f32_32x32x16_bf16 v[140:155], v[200:203], v[40:43], v[140:155]
    ds_read_b128 v[192:195], v3 offset:13312
    buffer_load_dwordx4 v1, s[68:71], s48 offen offset:2048 sc1 lds
    v_mul_f32 v220, v204, v9
    v_mul_f32 v221, v205, v9
    v_fma_f32 v220, v156, v6, v220
    s_waitcnt lgkmcnt(4)
    v_mfma_f32_32x32x16_bf16 v[140:155], v[172:175], v[44:47], v[140:155]
    ds_read_b128 v[196:199], v3 offset:14336
    v_fma_f32 v221, v157, v6, v221
    v_exp_f32 v220, v220
    v_exp_f32 v221, v221
    v_mfma_f32_32x32x16_bf16 v[140:155], v[176:179], v[48:51], v[140:155]
    ds_read_b128 v[200:203], v3 offset:15360
    v_mul_f32 v228, v212, v11
    v_mul_f32 v229, v213, v11
    v_add_f32 v220, 1.0, v220
    s_waitcnt lgkmcnt(4)
    v_mfma_f32_32x32x16_bf16 v[140:155], v[180:183], v[52:55], v[140:155]
    ds_read_b128 v[172:175], v3 offset:16384
    buffer_load_dwordx4 v1, s[68:71], s48 offen offset:3072 sc1 lds
    v_add_f32 v221, 1.0, v221
    v_rcp_f32 v220, v220
    v_rcp_f32 v221, v221
    v_mfma_f32_32x32x16_bf16 v[140:155], v[184:187], v[56:59], v[140:155]
    ds_read_b128 v[176:179], v3 offset:17408
    v_fma_f32 v228, v164, v10, v228
    v_fma_f32 v229, v165, v10, v229
    v_mul_f32 v228, v228, v220
    s_waitcnt lgkmcnt(4)
    v_mfma_f32_32x32x16_bf16 v[140:155], v[188:191], v[60:63], v[140:155]
    ds_read_b128 v[180:183], v3 offset:18432
    v_mul_f32 v229, v229, v221
    v_cvt_pk_bf16_f32 v248, v228, v229
    v_mfma_f32_32x32x16_bf16 v[140:155], v[192:195], v[64:67], v[140:155]
    ds_read_b128 v[184:187], v3 offset:19456
    v_mul_f32 v222, v206, v9
    v_mul_f32 v223, v207, v9
    v_fma_f32 v222, v158, v6, v222
    s_waitcnt lgkmcnt(4)
    v_mfma_f32_32x32x16_bf16 v[140:155], v[196:199], v[68:71], v[140:155]
    ds_read_b128 v[188:191], v3 offset:20480
    v_fma_f32 v223, v159, v6, v223
    v_exp_f32 v222, v222
    v_exp_f32 v223, v223
    v_mfma_f32_32x32x16_bf16 v[140:155], v[200:203], v[72:75], v[140:155]
    ds_read_b128 v[192:195], v3 offset:21504
    v_mul_f32 v230, v214, v11
    v_mul_f32 v231, v215, v11
    v_add_f32 v222, 1.0, v222
    s_waitcnt lgkmcnt(4)
    v_mfma_f32_32x32x16_bf16 v[140:155], v[172:175], v[76:79], v[140:155]
    ds_read_b128 v[196:199], v3 offset:22528
    v_add_f32 v223, 1.0, v223
    v_rcp_f32 v222, v222
    v_rcp_f32 v223, v223
    v_mfma_f32_32x32x16_bf16 v[140:155], v[176:179], v[80:83], v[140:155]
    ds_read_b128 v[200:203], v3 offset:23552
    v_fma_f32 v230, v166, v10, v230
    v_fma_f32 v231, v167, v10, v231
    v_mul_f32 v230, v230, v222
    s_waitcnt lgkmcnt(4)
    v_mfma_f32_32x32x16_bf16 v[140:155], v[180:183], v[84:87], v[140:155]
    ds_read_b128 v[172:175], v3 offset:24576
    v_mul_f32 v231, v231, v223
    v_cvt_pk_bf16_f32 v249, v230, v231
    v_mfma_f32_32x32x16_bf16 v[140:155], v[184:187], v[88:91], v[140:155]
    ds_read_b128 v[176:179], v3 offset:25600
    v_mul_f32 v224, v208, v9
    v_mul_f32 v225, v209, v9
    v_fma_f32 v224, v160, v6, v224
    s_waitcnt lgkmcnt(4)
    v_mfma_f32_32x32x16_bf16 v[140:155], v[188:191], v[92:95], v[140:155]
    s_cmp_ge_u32 s44, 5
    s_waitcnt vmcnt(8)
    s_cbranch_scc1 L_s3_special
    s_barrier
L_s3_back:
    ds_read_b128 v[180:183], v3 offset:26624
    v_fma_f32 v225, v161, v6, v225
    v_exp_f32 v224, v224
    v_exp_f32 v225, v225
    v_mfma_f32_32x32x16_bf16 v[140:155], v[192:195], v[96:99], v[140:155]
    ds_read_b128 v[184:187], v3 offset:27648
    v_mul_f32 v232, v216, v11
    v_mul_f32 v233, v217, v11
    v_add_f32 v224, 1.0, v224
    s_waitcnt lgkmcnt(4)
    v_mfma_f32_32x32x16_bf16 v[140:155], v[196:199], v[100:103], v[140:155]
    ds_read_b128 v[188:191], v3 offset:28672
    s_mov_b32 m0, s37
    s_nop 0
    buffer_load_dwordx4 v1, s[8:11], s36 offen offset:0 sc1 lds
    v_add_f32 v225, 1.0, v225
    v_rcp_f32 v224, v224
    v_rcp_f32 v225, v225
    v_mfma_f32_32x32x16_bf16 v[140:155], v[200:203], v[104:107], v[140:155]
    ds_read_b128 v[192:195], v3 offset:29696
    v_fma_f32 v232, v168, v10, v232
    v_fma_f32 v233, v169, v10, v233
    v_mul_f32 v232, v232, v224
    s_waitcnt lgkmcnt(4)
    v_mfma_f32_32x32x16_bf16 v[140:155], v[172:175], v[108:111], v[140:155]
    ds_read_b128 v[196:199], v3 offset:30720
    v_mul_f32 v233, v233, v225
    v_cvt_pk_bf16_f32 v250, v232, v233
    v_mfma_f32_32x32x16_bf16 v[140:155], v[176:179], v[112:115], v[140:155]
    ds_read_b128 v[200:203], v3 offset:31744
    buffer_load_dwordx4 v1, s[8:11], s36 offen offset:1024 sc1 lds
    v_mul_f32 v226, v210, v9
    v_mul_f32 v227, v211, v9
    v_fma_f32 v226, v162, v6, v226
    s_waitcnt lgkmcnt(4)
    v_mfma_f32_32x32x16_bf16 v[140:155], v[180:183], v[116:119], v[140:155]
    ds_read_b128 v[172:175], v4 offset:0
    v_fma_f32 v227, v163, v6, v227
    v_exp_f32 v226, v226
    v_exp_f32 v227, v227
    v_mfma_f32_32x32x16_bf16 v[140:155], v[184:187], v[120:123], v[140:155]
    ds_read_b128 v[176:179], v4 offset:1024
    v_mul_f32 v234, v218, v11
    v_mul_f32 v235, v219, v11
    v_add_f32 v226, 1.0, v226
    s_waitcnt lgkmcnt(4)
    v_mfma_f32_32x32x16_bf16 v[140:155], v[188:191], v[124:127], v[140:155]
    ds_read_b128 v[180:183], v4 offset:2048
    buffer_load_dwordx4 v1, s[8:11], s36 offen offset:2048 sc1 lds
    v_add_f32 v227, 1.0, v227
    v_rcp_f32 v226, v226
    v_rcp_f32 v227, v227
    v_mfma_f32_32x32x16_bf16 v[140:155], v[192:195], v[128:131], v[140:155]
    ds_read_b128 v[184:187], v4 offset:3072
    v_fma_f32 v234, v170, v10, v234
    v_fma_f32 v235, v171, v10, v235
    v_mul_f32 v234, v234, v226
    s_waitcnt lgkmcnt(4)
    v_mfma_f32_32x32x16_bf16 v[140:155], v[196:199], v[132:135], v[140:155]
    ds_read_b128 v[188:191], v4 offset:4096
    buffer_load_dwordx4 v1, s[8:11], s36 offen offset:3072 sc1 lds
    v_mul_f32 v235, v235, v227
    v_cvt_pk_bf16_f32 v251, v234, v235
    v_mfma_f32_32x32x16_bf16 v[156:171], v[200:203], v[136:139], v[140:155]
    ds_read_b128 v[192:195], v4 offset:5120
    s_add_u32 s48, s36, 4096
    s_add_u32 s49, s37, 4096
    s_mov_b32 s70, s10
    s_add_u32 s36, s36, 32768
    s_add_u32 s37, s37, 32768
    s_and_b32 s37, s37, 0x1ffff
    s_add_u32 s44, s44, 1
    v_mov_b32 v3, v4
    v_add_u32 v4, 32768, v4
    v_and_b32 v4, 0x1ffff, v4
    v_add_u32 v5, 128, v5
    buffer_store_dwordx4 v[248:251], v1, s[8:11], s45 offen sc1
    s_add_u32 s45, s45, 1024
    s_cmp_lt_u32 s44, 7
    s_cbranch_scc1 L_s3_loop
    s_branch L_s3_done
L_s3_special:
    s_cmp_eq_u32 s44, 6
    s_cbranch_scc1 L_s3_sp6
    s_waitcnt vmcnt(4)
    s_barrier
    s_lshl_b32 s27, s21, 7
    s_lshl_b32 s28, s22, 2
    s_add_u32 s27, s27, s28
    s_add_u32 s27, s27, 0x1305000
    s_cmp_lg_u32 s20, 0
    s_cbranch_scc1 L_fs_38
    v_mov_b32 v252, s23
    v_mov_b32 v253, 0
    s_mov_b64 exec, 1
    buffer_store_dword v252, v253, s[72:75], s27 offen sc1
    buffer_store_dword v252, v253, s[76:79], s27 offen
    s_mov_b64 exec, -1
L_fs_38:
    s_branch L_s3_back
L_s3_sp6:
    s_barrier
    v_and_b32 v253, 15, v2
    v_lshlrev_b32 v253, 2, v253
    s_lshl_b32 s83, s21, 7
    s_add_u32 s83, s83, 0x1305000
    buffer_load_dword v252, v253, s[8:11], s83 offen sc1
    s_branch L_s3_back
L_s3_done:
    ds_read_b128 v[204:207], v5 offset:0
    ds_read_b128 v[208:211], v5 offset:32
    ds_read_b128 v[212:215], v5 offset:64
    ds_read_b128 v[216:219], v5 offset:96
    s_waitcnt lgkmcnt(0)
    s_nop 7
    v_mul_f32 v220, v204, v9
    v_mul_f32 v221, v205, v9
    v_fma_f32 v220, v156, v6, v220
    v_fma_f32 v221, v157, v6, v221
    v_exp_f32 v220, v220
    v_exp_f32 v221, v221
    v_mul_f32 v228, v212, v11
    v_mul_f32 v229, v213, v11
    v_add_f32 v220, 1.0, v220
    v_add_f32 v221, 1.0, v221
    v_rcp_f32 v220, v220
    v_rcp_f32 v221, v221
    v_fma_f32 v228, v164, v10, v228
    v_fma_f32 v229, v165, v10, v229
    v_mul_f32 v228, v228, v220
    v_mul_f32 v229, v229, v221
    v_cvt_pk_bf16_f32 v248, v228, v229
    v_mul_f32 v222, v206, v9
    v_mul_f32 v223, v207, v9
    v_fma_f32 v222, v158, v6, v222
    v_fma_f32 v223, v159, v6, v223
    v_exp_f32 v222, v222
    v_exp_f32 v223, v223
    v_mul_f32 v230, v214, v11
    v_mul_f32 v231, v215, v11
    v_add_f32 v222, 1.0, v222
    v_add_f32 v223, 1.0, v223
    v_rcp_f32 v222, v222
    v_rcp_f32 v223, v223
    v_fma_f32 v230, v166, v10, v230
    v_fma_f32 v231, v167, v10, v231
    v_mul_f32 v230, v230, v222
    v_mul_f32 v231, v231, v223
    v_cvt_pk_bf16_f32 v249, v230, v231
    v_mul_f32 v224, v208, v9
    v_mul_f32 v225, v209, v9
    v_fma_f32 v224, v160, v6, v224
    v_fma_f32 v225, v161, v6, v225
    v_exp_f32 v224, v224
    v_exp_f32 v225, v225
    v_mul_f32 v232, v216, v11
    v_mul_f32 v233, v217, v11
    v_add_f32 v224, 1.0, v224
    v_add_f32 v225, 1.0, v225
    v_rcp_f32 v224, v224
    v_rcp_f32 v225, v225
    v_fma_f32 v232, v168, v10, v232
    v_fma_f32 v233, v169, v10, v233
    v_mul_f32 v232, v232, v224
    v_mul_f32 v233, v233, v225
    v_cvt_pk_bf16_f32 v250, v232, v233
    v_mul_f32 v226, v210, v9
    v_mul_f32 v227, v211, v9
    v_fma_f32 v226, v162, v6, v226
    v_fma_f32 v227, v163, v6, v227
    v_exp_f32 v226, v226
    v_exp_f32 v227, v227
    v_mul_f32 v234, v218, v11
    v_mul_f32 v235, v219, v11
    v_add_f32 v226, 1.0, v226
    v_add_f32 v227, 1.0, v227
    v_rcp_f32 v226, v226
    v_rcp_f32 v227, v227
    v_fma_f32 v234, v170, v10, v234
    v_fma_f32 v235, v171, v10, v235
    v_mul_f32 v234, v234, v226
    v_mul_f32 v235, v235, v227
    v_cvt_pk_bf16_f32 v251, v234, v235
    buffer_store_dwordx4 v[248:251], v1, s[8:11], s45 offen sc1
    s_waitcnt vmcnt(6)
    s_mov_b32 s29, 0
L_ap_39:
    v_cmp_ne_u32 vcc, s23, v252
    s_cbranch_vccz L_ad_40
    s_add_u32 s29, s29, 1
    s_cmp_ge_u32 s29, 32768
    s_cbranch_scc1 L_ad_40
    buffer_load_dword v252, v253, s[8:11], s83 offen sc1
    s_waitcnt vmcnt(0)
    s_branch L_ap_39
L_ad_40:
    s_mul_i32 s38, s20, 28672
    s_xor_b32 s37, s31, 1
    s_mul_i32 s39, s31, 114688
    s_add_u32 s39, s39, s38
    s_add_u32 s39, s39, 0xb00000
    v_add_u32 v3, s39, v1
    s_mul_i32 s39, s37, 114688
    s_add_u32 s39, s39, s38
    s_add_u32 s39, s39, 0xb00000
    v_add_u32 v4, s39, v1
    buffer_load_dwordx4 v[80:83], v3, s[8:11], s52 offen offset:0 sc1
    buffer_load_dwordx4 v[84:87], v4, s[8:11], s52 offen offset:0 sc1
    buffer_load_dwordx4 v[88:91], v3, s[8:11], s52 offen offset:1024 sc1
    buffer_load_dwordx4 v[92:95], v4, s[8:11], s52 offen offset:1024 sc1
    buffer_load_dwordx4 v[96:99], v3, s[8:11], s52 offen offset:2048 sc1
    buffer_load_dwordx4 v[100:103], v4, s[8:11], s52 offen offset:2048 sc1
    buffer_load_dwordx4 v[104:107], v3, s[8:11], s52 offen offset:3072 sc1
    buffer_load_dwordx4 v[108:111], v4, s[8:11], s52 offen offset:3072 sc1
    buffer_load_dwordx4 v[112:115], v3, s[8:11], s53 offen offset:3072 sc1
    buffer_load_dwordx4 v[116:119], v4, s[8:11], s53 offen offset:3072 sc1
    buffer_load_dwordx4 v[120:123], v3, s[8:11], s54 offen offset:0 sc1
    buffer_load_dwordx4 v[124:127], v4, s[8:11], s54 offen offset:0 sc1
    buffer_load_dwordx4 v[128:131], v3, s[8:11], s54 offen offset:1024 sc1
    buffer_load_dwordx4 v[132:135], v4, s[8:11], s54 offen offset:1024 sc1
    s_lshl_b32 s38, s20, 13
    v_add_u32 v5, s38, v1
    v_add_u32 v6, 65536, v5
    s_waitcnt vmcnt(12)
    s_barrier
    s_lshl_b32 s27, s21, 7
    s_lshl_b32 s28, s22, 2
    s_add_u32 s27, s27, s28
    s_add_u32 s27, s27, 0x1301400
    s_cmp_lg_u32 s20, 0
    s_cbranch_scc1 L_fs_41
    v_mov_b32 v150, s23
    v_mov_b32 v151, 0
    s_mov_b64 exec, 1
    buffer_store_dword v150, v151, s[72:75], s27 offen sc1
    buffer_store_dword v150, v151, s[76:79], s27 offen
    s_mov_b64 exec, -1
L_fs_41:
    v_mfma_f32_32x32x16_bf16 v[16:31], a[0:3], v[80:83], 0
    v_mfma_f32_32x32x16_bf16 v[32:47], a[112:115], v[80:83], 0
    v_mfma_f32_32x32x16_bf16 v[48:63], a[0:3], v[84:87], 0
    v_mfma_f32_32x32x16_bf16 v[64:79], a[112:115], v[84:87], 0
    buffer_load_dwordx4 v[80:83], v3, s[8:11], s54 offen offset:2048 sc1
    buffer_load_dwordx4 v[84:87], v4, s[8:11], s54 offen offset:2048 sc1
    ds_read_b128 a[64:67], v5 offset:32768
    ds_read_b128 a[68:71], v5 offset:33792
    ds_read_b128 a[72:75], v5 offset:34816
    s_waitcnt vmcnt(12)
    v_mfma_f32_32x32x16_bf16 v[16:31], a[4:7], v[88:91], v[16:31]
    v_mfma_f32_32x32x16_bf16 v[32:47], a[116:119], v[88:91], v[32:47]
    v_mfma_f32_32x32x16_bf16 v[48:63], a[4:7], v[92:95], v[48:63]
    v_mfma_f32_32x32x16_bf16 v[64:79], a[116:119], v[92:95], v[64:79]
    buffer_load_dwordx4 v[88:91], v3, s[8:11], s55 offen offset:2048 sc1
    buffer_load_dwordx4 v[92:95], v4, s[8:11], s55 offen offset:2048 sc1
    ds_read_b128 a[76:79], v5 offset:35840
    ds_read_b128 a[80:83], v6 offset:32768
    ds_read_b128 a[84:87], v6 offset:33792
    s_waitcnt vmcnt(12)
    v_mfma_f32_32x32x16_bf16 v[16:31], a[8:11], v[96:99], v[16:31]
    v_mfma_f32_32x32x16_bf16 v[32:47], a[120:123], v[96:99], v[32:47]
    v_mfma_f32_32x32x16_bf16 v[48:63], a[8:11], v[100:103], v[48:63]
    v_mfma_f32_32x32x16_bf16 v[64:79], a[120:123], v[100:103], v[64:79]
    buffer_load_dwordx4 v[96:99], v3, s[8:11], s55 offen offset:3072 sc1
    buffer_load_dwordx4 v[100:103], v4, s[8:11], s55 offen offset:3072 sc1
    ds_read_b128 a[88:91], v6 offset:34816
    ds_read_b128 a[92:95], v6 offset:35840
    ds_read_b128 a[96:99], v6 offset:36864
    v_and_b32 v149, 31, v2
    v_lshrrev_b32 v150, 5, v2
    v_and_b32 v151, 15, v2
    v_xor_b32 v150, v150, v151
    s_waitcnt vmcnt(12)
    v_mfma_f32_32x32x16_bf16 v[16:31], a[12:15], v[104:107], v[16:31]
    v_mfma_f32_32x32x16_bf16 v[32:47], a[124:127], v[104:107], v[32:47]
    v_mfma_f32_32x32x16_bf16 v[48:63], a[12:15], v[108:111], v[48:63]
    v_mfma_f32_32x32x16_bf16 v[64:79], a[124:127], v[108:111], v[64:79]
    buffer_load_dwordx4 v[104:107], v3, s[8:11], s56 offen offset:0 sc1
    buffer_load_dwordx4 v[108:111], v4, s[8:11], s56 offen offset:0 sc1
    ds_read_b128 a[100:103], v6 offset:37888
    ds_read_b128 a[104:107], v6 offset:38912
    ds_read_b128 a[108:111], v6 offset:39936
    v_lshlrev_b32 v150, 4, v150
    v_lshl_add_u32 v149, v149, 8, v150
    s_and_b32 s36, s20, 1
    s_waitcnt vmcnt(12)
    v_mfma_f32_32x32x16_bf16 v[16:31], a[28:31], v[112:115], v[16:31]
    v_mfma_f32_32x32x16_bf16 v[32:47], a[140:143], v[112:115], v[32:47]
    v_mfma_f32_32x32x16_bf16 v[48:63], a[28:31], v[116:119], v[48:63]
    v_mfma_f32_32x32x16_bf16 v[64:79], a[140:143], v[116:119], v[64:79]
    buffer_load_dwordx4 v[112:115], v3, s[8:11], s56 offen offset:1024 sc1
    buffer_load_dwordx4 v[116:119], v4, s[8:11], s56 offen offset:1024 sc1
    ds_read_b128 a[192:195], v5 offset:0
    ds_read_b128 a[196:199], v5 offset:1024
    ds_read_b128 a[200:203], v5 offset:2048
    s_lshr_b32 s37, s20, 1
    s_lshl_b32 s38, s20, 14
    s_xor_b32 s39, s37, 0
    s_lshl_b32 s39, s39, 13
    s_waitcnt vmcnt(12)
    v_mfma_f32_32x32x16_bf16 v[16:31], a[32:35], v[120:123], v[16:31]
    v_mfma_f32_32x32x16_bf16 v[32:47], a[144:147], v[120:123], v[32:47]
    v_mfma_f32_32x32x16_bf16 v[48:63], a[32:35], v[124:127], v[48:63]
    v_mfma_f32_32x32x16_bf16 v[64:79], a[144:147], v[124:127], v[64:79]
    buffer_load_dwordx4 v[120:123], v3, s[8:11], s57 offen offset:1024 sc1
    buffer_load_dwordx4 v[124:127], v4, s[8:11], s57 offen offset:1024 sc1
    s_lshl_b32 s83, s21, 7
    s_add_u32 s83, s83, 0x1301400
    buffer_load_dword v252, v253, s[8:11], s83 offen sc1
    ds_read_b128 a[204:207], v5 offset:3072
    ds_read_b128 a[208:211], v5 offset:4096
    ds_read_b128 a[212:215], v5 offset:5120
    s_add_u32 s39, s39, s38
    v_add_u32 v140, s39, v149
    s_xor_b32 s39, s36, 0
    s_waitcnt vmcnt(13)
    v_mfma_f32_32x32x16_bf16 v[16:31], a[36:39], v[128:131], v[16:31]
    v_mfma_f32_32x32x16_bf16 v[32:47], a[148:151], v[128:131], v[32:47]
    v_mfma_f32_32x32x16_bf16 v[48:63], a[36:39], v[132:135], v[48:63]
    v_mfma_f32_32x32x16_bf16 v[64:79], a[148:151], v[132:135], v[64:79]
    buffer_load_dwordx4 v[128:131], v3, s[8:11], s57 offen offset:2048 sc1
    buffer_load_dwordx4 v[132:135], v4, s[8:11], s57 offen offset:2048 sc1
    ds_read_b128 a[216:219], v5 offset:6144
    ds_read_b128 a[220:223], v5 offset:7168
    s_lshl_b32 s39, s39, 7
    v_xor_b32 v140, s39, v140
    s_xor_b32 s39, s37, 0
    s_lshl_b32 s39, s39, 13
    s_waitcnt vmcnt(13)
    v_mfma_f32_32x32x16_bf16 v[16:31], a[40:43], v[80:83], v[16:31]
    v_mfma_f32_32x32x16_bf16 v[32:47], a[152:155], v[80:83], v[32:47]
    v_mfma_f32_32x32x16_bf16 v[48:63], a[40:43], v[84:87], v[48:63]
    v_mfma_f32_32x32x16_bf16 v[64:79], a[152:155], v[84:87], v[64:79]
    buffer_load_dwordx4 v[80:83], v3, s[8:11], s57 offen offset:3072 sc1
    buffer_load_dwordx4 v[84:87], v4, s[8:11], s57 offen offset:3072 sc1
    s_add_u32 s39, s39, s38
    v_add_u32 v141, s39, v149
    s_xor_b32 s39, s36, 1
    s_waitcnt vmcnt(13) lgkmcnt(0)
    v_mfma_f32_32x32x16_bf16 v[16:31], a[56:59], v[88:91], v[16:31]
    v_mfma_f32_32x32x16_bf16 v[32:47], a[168:171], v[88:91], v[32:47]
    v_mfma_f32_32x32x16_bf16 v[48:63], a[56:59], v[92:95], v[48:63]
    v_mfma_f32_32x32x16_bf16 v[64:79], a[168:171], v[92:95], v[64:79]
    buffer_load_dwordx4 v[88:91], v3, s[8:11], s58 offen offset:0 sc1
    buffer_load_dwordx4 v[92:95], v4, s[8:11], s58 offen offset:0 sc1
    s_lshl_b32 s39, s39, 7
    v_xor_b32 v141, s39, v141
    s_xor_b32 s39, s37, 1
    s_lshl_b32 s39, s39, 13
    s_waitcnt vmcnt(13)
    v_mfma_f32_32x32x16_bf16 v[16:31], a[60:63], v[96:99], v[16:31]
    v_mfma_f32_32x32x16_bf16 v[32:47], a[172:175], v[96:99], v[32:47]
    v_mfma_f32_32x32x16_bf16 v[48:63], a[60:63], v[100:103], v[48:63]
    v_mfma_f32_32x32x16_bf16 v[64:79], a[172:175], v[100:103], v[64:79]
    s_add_u32 s39, s39, s38
    v_add_u32 v142, s39, v149
    s_xor_b32 s39, s36, 0
    s_waitcnt vmcnt(11)
    v_mfma_f32_32x32x16_bf16 v[16:31], a[64:67], v[104:107], v[16:31]
    v_mfma_f32_32x32x16_bf16 v[32:47], a[176:179], v[104:107], v[32:47]
    v_mfma_f32_32x32x16_bf16 v[48:63], a[64:67], v[108:111], v[48:63]
    v_mfma_f32_32x32x16_bf16 v[64:79], a[176:179], v[108:111], v[64:79]
    s_lshl_b32 s39, s39, 7
    v_xor_b32 v142, s39, v142
    s_xor_b32 s39, s37, 1
    s_lshl_b32 s39, s39, 13
    s_waitcnt vmcnt(9)
    v_mfma_f32_32x32x16_bf16 v[16:31], a[68:71], v[112:115], v[16:31]
    v_mfma_f32_32x32x16_bf16 v[32:47], a[180:183], v[112:115], v[32:47]
    v_mfma_f32_32x32x16_bf16 v[48:63], a[68:71], v[116:119], v[48:63]
    v_mfma_f32_32x32x16_bf16 v[64:79], a[180:183], v[116:119], v[64:79]
    s_add_u32 s39, s39, s38
    v_add_u32 v143, s39, v149
    s_xor_b32 s39, s36, 1
    s_waitcnt vmcnt(7)
    s_waitcnt vmcnt(6)
    s_mov_b32 s29, 0
L_bp_42:
    v_cmp_ne_u32 vcc, s23, v252
    s_cbranch_vccz L_bd_43
    s_add_u32 s29, s29, 1
    s_cmp_ge_u32 s29, 32768
    s_cbranch_scc1 L_bd_43
    buffer_load_dword v252, v253, s[8:11], s83 offen sc1
    s_waitcnt vmcnt(0)
    s_branch L_bp_42
L_bd_43:
    buffer_load_dwordx4 v[96:99], v3, s[8:11], s53 offen offset:0 sc1
    buffer_load_dwordx4 v[100:103], v4, s[8:11], s53 offen offset:0 sc1
    buffer_load_dwordx4 v[104:107], v3, s[8:11], s53 offen offset:1024 sc1
    buffer_load_dwordx4 v[108:111], v4, s[8:11], s53 offen offset:1024 sc1
    buffer_load_dwordx4 v[112:115], v3, s[8:11], s53 offen offset:2048 sc1
    buffer_load_dwordx4 v[116:119], v4, s[8:11], s53 offen offset:2048 sc1
    v_mfma_f32_32x32x16_bf16 v[16:31], a[84:87], v[120:123], v[16:31]
    v_mfma_f32_32x32x16_bf16 v[32:47], a[196:199], v[120:123], v[32:47]
    v_mfma_f32_32x32x16_bf16 v[48:63], a[84:87], v[124:127], v[48:63]
    v_mfma_f32_32x32x16_bf16 v[64:79], a[196:199], v[124:127], v[64:79]
    buffer_load_dwordx4 v[120:123], v3, s[8:11], s54 offen offset:3072 sc1
    buffer_load_dwordx4 v[124:127], v4, s[8:11], s54 offen offset:3072 sc1
    s_lshl_b32 s39, s39, 7
    v_xor_b32 v143, s39, v143
    v_lshrrev_b32 v149, 3, v2
    v_and_b32 v150, 7, v2
    s_waitcnt vmcnt(12)
    v_mfma_f32_32x32x16_bf16 v[16:31], a[88:91], v[128:131], v[16:31]
    v_mfma_f32_32x32x16_bf16 v[32:47], a[200:203], v[128:131], v[32:47]
    v_mfma_f32_32x32x16_bf16 v[48:63], a[88:91], v[132:135], v[48:63]
    v_mfma_f32_32x32x16_bf16 v[64:79], a[200:203], v[132:135], v[64:79]
    buffer_load_dwordx4 v[128:131], v3, s[8:11], s55 offen offset:0 sc1
    buffer_load_dwordx4 v[132:135], v4, s[8:11], s55 offen offset:0 sc1
    v_lshlrev_b32 v144, 1, v150
    v_xor_b32 v144, v144, v149
    v_lshlrev_b32 v144, 4, v144
    s_waitcnt vmcnt(12)
    v_mfma_f32_32x32x16_bf16 v[16:31], a[92:95], v[80:83], v[16:31]
    v_mfma_f32_32x32x16_bf16 v[32:47], a[204:207], v[80:83], v[32:47]
    v_mfma_f32_32x32x16_bf16 v[48:63], a[92:95], v[84:87], v[48:63]
    v_mfma_f32_32x32x16_bf16 v[64:79], a[204:207], v[84:87], v[64:79]
    buffer_load_dwordx4 v[80:83], v3, s[8:11], s55 offen offset:1024 sc1
    buffer_load_dwordx4 v[84:87], v4, s[8:11], s55 offen offset:1024 sc1
    v_lshl_add_u32 v144, v149, 8, v144
    s_lshl_b32 s39, s20, 12
    v_add_u32 v144, s39, v144
    v_xor_b32 v145, 16, v144
    s_waitcnt vmcnt(12)
    v_mfma_f32_32x32x16_bf16 v[16:31], a[96:99], v[88:91], v[16:31]
    v_mfma_f32_32x32x16_bf16 v[32:47], a[208:211], v[88:91], v[32:47]
    v_mfma_f32_32x32x16_bf16 v[48:63], a[96:99], v[92:95], v[48:63]
    v_mfma_f32_32x32x16_bf16 v[64:79], a[208:211], v[92:95], v[64:79]
    buffer_load_dwordx4 v[88:91], v3, s[8:11], s56 offen offset:2048 sc1
    buffer_load_dwordx4 v[92:95], v4, s[8:11], s56 offen offset:2048 sc1
    v_xor_b32 v146, 128, v144
    v_add_u32 v146, 2048, v146
    v_xor_b32 v147, 16, v146
    s_waitcnt vmcnt(12)
    v_mfma_f32_32x32x16_bf16 v[16:31], a[16:19], v[96:99], v[16:31]
    v_mfma_f32_32x32x16_bf16 v[32:47], a[128:131], v[96:99], v[32:47]
    v_mfma_f32_32x32x16_bf16 v[48:63], a[16:19], v[100:103], v[48:63]
    v_mfma_f32_32x32x16_bf16 v[64:79], a[128:131], v[100:103], v[64:79]
    buffer_load_dwordx4 v[96:99], v3, s[8:11], s56 offen offset:3072 sc1
    buffer_load_dwordx4 v[100:103], v4, s[8:11], s56 offen offset:3072 sc1
    s_mov_b32 s12, s50
    s_and_b32 s13, s51, 0xffff
    s_mov_b32 s14, 0x200000
    s_mov_b32 s15, 0x20000
    s_waitcnt vmcnt(12)
    v_mfma_f32_32x32x16_bf16 v[16:31], a[20:23], v[104:107], v[16:31]
    v_mfma_f32_32x32x16_bf16 v[32:47], a[132:135], v[104:107], v[32:47]
    v_mfma_f32_32x32x16_bf16 v[48:63], a[20:23], v[108:111], v[48:63]
    v_mfma_f32_32x32x16_bf16 v[64:79], a[132:135], v[108:111], v[64:79]
    buffer_load_dwordx4 v[104:107], v3, s[8:11], s57 offen offset:0 sc1
    buffer_load_dwordx4 v[108:111], v4, s[8:11], s57 offen offset:0 sc1
    v_lshlrev_b32 v148, 10, v149
    v_lshl_add_u32 v148, v150, 4, v148
    s_lshl_b32 s38, s26, 16
    s_waitcnt vmcnt(12)
    v_mfma_f32_32x32x16_bf16 v[16:31], a[24:27], v[112:115], v[16:31]
    v_mfma_f32_32x32x16_bf16 v[32:47], a[136:139], v[112:115], v[32:47]
    v_mfma_f32_32x32x16_bf16 v[48:63], a[24:27], v[116:119], v[48:63]
    v_mfma_f32_32x32x16_bf16 v[64:79], a[136:139], v[116:119], v[64:79]
    buffer_load_dwordx4 v[112:115], v3, s[8:11], s58 offen offset:1024 sc1
    buffer_load_dwordx4 v[116:119], v4, s[8:11], s58 offen offset:1024 sc1
    s_lshl_b32 s39, s25, 7
    s_add_u32 s38, s38, s39
    s_lshl_b32 s39, s20, 14
    s_add_u32 s38, s38, s39
    s_waitcnt vmcnt(12)
    v_mfma_f32_32x32x16_bf16 v[16:31], a[44:47], v[120:123], v[16:31]
    v_mfma_f32_32x32x16_bf16 v[32:47], a[156:159], v[120:123], v[32:47]
    v_mfma_f32_32x32x16_bf16 v[48:63], a[44:47], v[124:127], v[48:63]
    v_mfma_f32_32x32x16_bf16 v[64:79], a[156:159], v[124:127], v[64:79]
    buffer_load_dwordx4 v[120:123], v3, s[8:11], s58 offen offset:2048 sc1
    buffer_load_dwordx4 v[124:127], v4, s[8:11], s58 offen offset:2048 sc1
    s_add_u32 s39, s38, 8192
    v_lshlrev_b32 v152, 16, v240
    v_and_b32 v153, 0xffff0000, v240
    s_waitcnt vmcnt(12)
    v_mfma_f32_32x32x16_bf16 v[16:31], a[48:51], v[128:131], v[16:31]
    v_mfma_f32_32x32x16_bf16 v[32:47], a[160:163], v[128:131], v[32:47]
    v_mfma_f32_32x32x16_bf16 v[48:63], a[48:51], v[132:135], v[48:63]
    v_mfma_f32_32x32x16_bf16 v[64:79], a[160:163], v[132:135], v[64:79]
    buffer_load_dwordx4 v[128:131], v3, s[8:11], s58 offen offset:3072 sc1
    buffer_load_dwordx4 v[132:135], v4, s[8:11], s58 offen offset:3072 sc1
    v_lshlrev_b32 v154, 16, v241
    v_and_b32 v155, 0xffff0000, v241
    v_lshlrev_b32 v156, 16, v242
    v_and_b32 v157, 0xffff0000, v242
    s_waitcnt vmcnt(12)
    v_mfma_f32_32x32x16_bf16 v[16:31], a[52:55], v[80:83], v[16:31]
    v_mfma_f32_32x32x16_bf16 v[32:47], a[164:167], v[80:83], v[32:47]
    v_mfma_f32_32x32x16_bf16 v[48:63], a[52:55], v[84:87], v[48:63]
    v_mfma_f32_32x32x16_bf16 v[64:79], a[164:167], v[84:87], v[64:79]
    v_lshlrev_b32 v158, 16, v243
    v_and_b32 v159, 0xffff0000, v243
    v_lshlrev_b32 v160, 16, v244
    s_waitcnt vmcnt(10)
    v_mfma_f32_32x32x16_bf16 v[16:31], a[72:75], v[88:91], v[16:31]
    v_mfma_f32_32x32x16_bf16 v[32:47], a[184:187], v[88:91], v[32:47]
    v_mfma_f32_32x32x16_bf16 v[48:63], a[72:75], v[92:95], v[48:63]
    v_mfma_f32_32x32x16_bf16 v[64:79], a[184:187], v[92:95], v[64:79]
    v_and_b32 v161, 0xffff0000, v244
    v_lshlrev_b32 v162, 16, v245
    v_and_b32 v163, 0xffff0000, v245
    v_lshlrev_b32 v164, 16, v246
    s_waitcnt vmcnt(8)
    v_mfma_f32_32x32x16_bf16 v[16:31], a[76:79], v[96:99], v[16:31]
    v_mfma_f32_32x32x16_bf16 v[32:47], a[188:191], v[96:99], v[32:47]
    v_mfma_f32_32x32x16_bf16 v[48:63], a[76:79], v[100:103], v[48:63]
    v_mfma_f32_32x32x16_bf16 v[64:79], a[188:191], v[100:103], v[64:79]
    v_and_b32 v165, 0xffff0000, v246
    v_lshlrev_b32 v166, 16, v247
    v_and_b32 v167, 0xffff0000, v247
    s_waitcnt vmcnt(6)
    v_mfma_f32_32x32x16_bf16 v[16:31], a[80:83], v[104:107], v[16:31]
    v_mfma_f32_32x32x16_bf16 v[32:47], a[192:195], v[104:107], v[32:47]
    v_mfma_f32_32x32x16_bf16 v[48:63], a[80:83], v[108:111], v[48:63]
    v_mfma_f32_32x32x16_bf16 v[64:79], a[192:195], v[108:111], v[64:79]
    s_waitcnt vmcnt(4)
    v_mfma_f32_32x32x16_bf16 v[16:31], a[100:103], v[112:115], v[16:31]
    v_mfma_f32_32x32x16_bf16 v[32:47], a[212:215], v[112:115], v[32:47]
    v_mfma_f32_32x32x16_bf16 v[48:63], a[100:103], v[116:119], v[48:63]
    v_mfma_f32_32x32x16_bf16 v[64:79], a[212:215], v[116:119], v[64:79]
    s_waitcnt vmcnt(2)
    v_mfma_f32_32x32x16_bf16 v[16:31], a[104:107], v[120:123], v[16:31]
    v_mfma_f32_32x32x16_bf16 v[32:47], a[216:219], v[120:123], v[32:47]
    v_mfma_f32_32x32x16_bf16 v[48:63], a[104:107], v[124:127], v[48:63]
    v_mfma_f32_32x32x16_bf16 v[64:79], a[216:219], v[124:127], v[64:79]
    s_waitcnt vmcnt(0)
    v_mfma_f32_32x32x16_bf16 v[16:31], a[108:111], v[128:131], v[16:31]
    v_mfma_f32_32x32x16_bf16 v[32:47], a[220:223], v[128:131], v[32:47]
    v_mfma_f32_32x32x16_bf16 v[48:63], a[108:111], v[132:135], v[48:63]
    v_mfma_f32_32x32x16_bf16 v[64:79], a[220:223], v[132:135], v[64:79]
    s_barrier
    s_nop 7
    v_pk_add_f32 v[16:17], v[16:17], v[152:153]
    v_pk_add_f32 v[18:19], v[18:19], v[154:155]
    v_pk_add_f32 v[20:21], v[20:21], v[156:157]
    v_pk_add_f32 v[22:23], v[22:23], v[158:159]
    v_pk_add_f32 v[24:25], v[24:25], v[160:161]
    v_pk_add_f32 v[26:27], v[26:27], v[162:163]
    v_pk_add_f32 v[28:29], v[28:29], v[164:165]
    v_pk_add_f32 v[30:31], v[30:31], v[166:167]
    ds_write_b128 v140, v[16:19]
    v_xor_b32 v101, 32, v140
    ds_write_b128 v101, v[20:23]
    v_xor_b32 v102, 64, v140
    ds_write_b128 v102, v[24:27]
    v_xor_b32 v103, 96, v140
    ds_write_b128 v103, v[28:31]
    ds_write_b128 v141, v[32:35]
    v_xor_b32 v101, 32, v141
    ds_write_b128 v101, v[36:39]
    v_xor_b32 v102, 64, v141
    ds_write_b128 v102, v[40:43]
    v_xor_b32 v103, 96, v141
    ds_write_b128 v103, v[44:47]
    ds_write_b128 v142, v[48:51]
    v_xor_b32 v101, 32, v142
    ds_write_b128 v101, v[52:55]
    v_xor_b32 v102, 64, v142
    ds_write_b128 v102, v[56:59]
    v_xor_b32 v103, 96, v142
    ds_write_b128 v103, v[60:63]
    ds_write_b128 v143, v[64:67]
    v_xor_b32 v101, 32, v143
    ds_write_b128 v101, v[68:71]
    v_xor_b32 v102, 64, v143
    ds_write_b128 v102, v[72:75]
    v_xor_b32 v103, 96, v143
    ds_write_b128 v103, v[76:79]
    s_waitcnt lgkmcnt(0)
    s_barrier
    ds_read_b128 v[80:83], v144 offset:0
    ds_read_b128 v[84:87], v145 offset:0
    ds_read_b128 v[88:91], v146 offset:0
    ds_read_b128 v[92:95], v147 offset:0
    ds_read_b128 v[96:99], v144 offset:16384
    ds_read_b128 v[100:103], v145 offset:16384
    ds_read_b128 v[104:107], v146 offset:16384
    ds_read_b128 v[108:111], v147 offset:16384
    ds_read_b128 v[112:115], v144 offset:32768
    ds_read_b128 v[116:119], v145 offset:32768
    ds_read_b128 v[120:123], v146 offset:32768
    ds_read_b128 v[124:127], v147 offset:32768
    ds_read_b128 v[128:131], v144 offset:49152
    ds_read_b128 v[132:135], v145 offset:49152
    ds_read_b128 v[136:139], v146 offset:49152
    ds_read_b128 v[140:143], v147 offset:49152
    s_waitcnt lgkmcnt(8)
    v_pk_add_f32 v[80:81], v[80:81], v[96:97]
    v_pk_add_f32 v[82:83], v[82:83], v[98:99]
    v_pk_add_f32 v[84:85], v[84:85], v[100:101]
    v_pk_add_f32 v[86:87], v[86:87], v[102:103]
    v_pk_add_f32 v[88:89], v[88:89], v[104:105]
    v_pk_add_f32 v[90:91], v[90:91], v[106:107]
    v_pk_add_f32 v[92:93], v[92:93], v[108:109]
    v_pk_add_f32 v[94:95], v[94:95], v[110:111]
    s_waitcnt lgkmcnt(4)
    v_pk_add_f32 v[80:81], v[80:81], v[112:113]
    v_pk_add_f32 v[82:83], v[82:83], v[114:115]
    v_pk_add_f32 v[84:85], v[84:85], v[116:117]
    v_pk_add_f32 v[86:87], v[86:87], v[118:119]
    v_pk_add_f32 v[88:89], v[88:89], v[120:121]
    v_pk_add_f32 v[90:91], v[90:91], v[122:123]
    v_pk_add_f32 v[92:93], v[92:93], v[124:125]
    v_pk_add_f32 v[94:95], v[94:95], v[126:127]
    s_waitcnt lgkmcnt(0)
    v_pk_add_f32 v[80:81], v[80:81], v[128:129]
    v_pk_add_f32 v[82:83], v[82:83], v[130:131]
    v_pk_add_f32 v[84:85], v[84:85], v[132:133]
    v_pk_add_f32 v[86:87], v[86:87], v[134:135]
    v_pk_add_f32 v[88:89], v[88:89], v[136:137]
    v_pk_add_f32 v[90:91], v[90:91], v[138:139]
    v_pk_add_f32 v[92:93], v[92:93], v[140:141]
    v_pk_add_f32 v[94:95], v[94:95], v[142:143]
    v_cvt_pk_bf16_f32 v32, v80, v81
    v_cvt_pk_bf16_f32 v33, v82, v83
    v_cvt_pk_bf16_f32 v34, v84, v85
    v_cvt_pk_bf16_f32 v35, v86, v87
    v_cvt_pk_bf16_f32 v36, v88, v89
    v_cvt_pk_bf16_f32 v37, v90, v91
    v_cvt_pk_bf16_f32 v38, v92, v93
    v_cvt_pk_bf16_f32 v39, v94, v95
    buffer_store_dwordx4 v[32:35], v148, s[12:15], s38 offen nt
    buffer_store_dwordx4 v[36:39], v148, s[12:15], s39 offen nt
L_end:
    s_endpgm
.section .rodata,"a"
.p2align 6
.amdhsa_kernel sequential_preLN__sliding_local_dilated__glu_gated_glu__prompt_kernel
  .amdhsa_next_free_vgpr 512
  .amdhsa_next_free_sgpr 102
  .amdhsa_accum_offset 256
  .amdhsa_group_segment_fixed_size 0
  .amdhsa_kernarg_size 80
  .amdhsa_user_sgpr_count 2
  .amdhsa_user_sgpr_kernarg_segment_ptr 1
  .amdhsa_system_sgpr_workgroup_id_x 1
  .amdhsa_float_denorm_mode_32 3
  .amdhsa_float_denorm_mode_16_64 3
.end_amdhsa_kernel
```
